```python
import torch

def _softmax(x, axis=-1):
    return torch.softmax(x, dim=axis)
def _gelu(x):
    return torch.nn.functional.gelu(x, approximate="tanh")
def _silu(x):
    return torch.nn.functional.silu(x)
def _sigmoid(x):
    return torch.sigmoid(x)
def _layernorm(x, axis=-1, eps=1e-5):
    m = x.mean(dim=axis, keepdim=True)
    v = x.var(dim=axis, keepdim=True, unbiased=False)
    return (x - m) / torch.sqrt(v + eps)
def _scatter_add(tgt, idx, src, axis=0):
    return tgt.clone().index_add_(axis, idx, src)
def _segment_sum(src, seg, n):
    out = torch.zeros((n,) + src.shape[1:], dtype=src.dtype)
    return out.index_add_(0, seg, src)
def _pad(x, pw):
    flat = tuple(v for pair in reversed(pw) for v in pair)
    return torch.nn.functional.pad(x, flat)

kernel_name = 'gated_mix__sliding_block__swiglu_ffn__prompt'

def setup_inputs():

    _w = (lambda a: (lambda t: t.to(torch.bfloat16) if t.is_floating_point() else t)(torch.as_tensor(a)))
    def _A_setup():
        B, S, D = 1, 2048, 640
        return {
            "x": _w((lambda *s: torch.randn(*s, dtype=torch.bfloat16) * 0.05)(B, S, D)),
            "wqkv": _w((lambda *s: torch.randn(*s, dtype=torch.bfloat16) * 1.6)(D, 3 * D)),
            "wo": _w((lambda *s: torch.randn(*s, dtype=torch.bfloat16) * 0.05)(D, D)),
        }
    _A_in = _A_setup()

    def _B_setup():
        B, S, D, F = 1, 2048, 640, 1728
        return {
            "x": _w((lambda *s: torch.randn(*s, dtype=torch.bfloat16) * 0.05)(B, S, D)),
            "w_gate": _w((lambda *s: torch.randn(*s, dtype=torch.bfloat16) * 0.4)(D, F)),
            "w_up": _w((lambda *s: torch.randn(*s, dtype=torch.bfloat16) * 0.4)(D, F)),
            "w_down": _w((lambda *s: torch.randn(*s, dtype=torch.bfloat16) * 0.4)(F, D)),
        }
    _B_in = _B_setup()

    return {
        "A_x": _A_in["x"],
        "A_wqkv": _A_in["wqkv"],
        "A_wo": _A_in["wo"],
        "B_x": _B_in["x"],
        "B_w_gate": _B_in["w_gate"],
        "B_w_up": _B_in["w_up"],
        "B_w_down": _B_in["w_down"],
        "gate_w": _w((lambda *s: torch.randn(*s, dtype=torch.bfloat16) * 0.05)(640) * 16.0),
    }

def reference(A_x, A_wqkv, A_wo, B_x, B_w_gate, B_w_up, B_w_down, gate_w):
    def _A_ref(x, wqkv, wo):
        B, S, D = x.shape
        H = 32; Dh = D // H; W = 256
        qkv = (lambda x, *d: x.permute(*d))((x @ wqkv).reshape(B, S, 3, H, Dh), 2, 0, 3, 1, 4)
        q, k, v = qkv[0], qkv[1], qkv[2]
        scores = torch.einsum("bhqd,bhkd->bhqk", q, k) * (Dh ** -0.5)
        idx = torch.arange(S)
        mask = (idx[:, None] - idx[None, :] >= 0) & (idx[:, None] - idx[None, :] < W)
        scores = torch.where(mask[None, None], scores, -1e9)
        p = _softmax(scores, axis=-1)
        o = torch.einsum("bhqk,bhkd->bhqd", p, v)
        return (lambda x, *d: x.permute(*d))(o, 0, 2, 1, 3).reshape(B, S, D) @ wo

    def _B_ref(x, w_gate, w_up, w_down):
        g = _silu(x @ w_gate)
        u = x @ w_up
        return (g * u) @ w_down

    x = A_x
    g = _sigmoid((x * gate_w).sum(-1, keepdims=True))
    a = _A_ref(x, A_wqkv, A_wo)
    b = _B_ref(x, B_w_gate, B_w_up, B_w_down)
    return g * a + (1 - g) * b
```

```asm
; @launch kernel=k1_kernel grid=(704,1,1) block=(256,1,1) lds=65536
; @launch kernel=k2_kernel grid=(1184,1,1) block=(256,1,1) lds=73728
; @launch kernel=k3_kernel grid=(160,1,1) block=(256,1,1) lds=73728
.amdgcn_target "amdgcn-amd-amdhsa--gfx950"
.text
.globl k1_kernel
.p2align 8
.type k1_kernel,@function
k1_kernel:
    s_load_dwordx16 s[44:59], s[0:1], 0
    s_load_dwordx4 s[60:63], s[0:1], 64
    s_load_dwordx2 s[64:65], s[0:1], 80
    s_waitcnt lgkmcnt(0)
    s_cmp_ge_u32 s2, 704
    s_cbranch_scc1 k1_end
    s_mov_b32 s20, s64
    s_and_b32 s21, s65, 0xffff
    s_mov_b32 s22, 268435456
    s_mov_b32 s23, 0x20000
    s_cmp_lt_u32 s2, 32
    s_cbranch_scc1 k1_g
    s_sub_u32 s2, s2, 32
    s_mov_b32 s8, s44
    s_and_b32 s9, s45, 0xffff
    s_mov_b32 s10, 2621440
    s_mov_b32 s11, 0x20000
    s_and_b32 s41, s2, 15
    s_lshr_b32 s42, s2, 4
    s_mul_i32 s31, s41, 163840
    s_cmp_ge_u32 s42, 15
    s_cbranch_scc1 k1_ff
    s_mov_b32 s12, s46
    s_and_b32 s13, s47, 0xffff
    s_mov_b32 s14, 2457600
    s_mov_b32 s15, 0x20000
    s_mov_b32 s16, s46
    s_and_b32 s17, s47, 0xffff
    s_mov_b32 s18, 2457600
    s_mov_b32 s19, 0x20000
    s_mov_b32 s30, 3840
    s_lshl_b32 s32, s42, 8
    s_add_u32 s33, s32, 128
    s_branch k1_go
k1_ff:
    s_mov_b32 s12, s52
    s_and_b32 s13, s53, 0xffff
    s_mov_b32 s14, 2211840
    s_mov_b32 s15, 0x20000
    s_mov_b32 s16, s54
    s_and_b32 s17, s55, 0xffff
    s_mov_b32 s18, 2211840
    s_mov_b32 s19, 0x20000
    s_mov_b32 s30, 3456
    s_sub_u32 s32, s42, 15
    s_lshl_b32 s32, s32, 7
    s_mov_b32 s33, s32
k1_go:
    v_lshrrev_b32 v1, 6, v0
    v_and_b32 v2, 63, v0
    s_nop 0
    v_readfirstlane_b32 s36, v1
    v_lshrrev_b32 v3, 3, v2
    v_and_b32 v4, 7, v2
    s_mul_i32 s37, s36, 32
    v_xor_b32 v5, v4, v3
    v_lshlrev_b32 v5, 4, v5
    v_add_u32 v6, s37, v3
    s_mov_b32 s27, 1280
    v_mul_lo_u32 v6, v6, s27
    v_add_u32 v10, v6, v5
    s_lshl_b32 s27, s36, 4
    v_add_u32 v6, s27, v3
    v_and_b32 v7, 2, v3
    v_xor_b32 v7, v7, v4
    v_mul_lo_u32 v8, v6, s30
    v_lshl_add_u32 v11, v7, 4, v8
    v_add_u32 v6, 8, v6
    v_xor_b32 v7, 4, v7
    v_mul_lo_u32 v8, v6, s30
    v_lshl_add_u32 v12, v7, 4, v8
    s_mul_i32 s38, s36, 4096
    s_lshl_b32 s39, s36, 11
    s_add_u32 s39, s39, 16384
    s_lshl_b32 s40, s30, 6
    s_lshr_b32 s34, s36, 1
    s_and_b32 s35, s36, 1
    v_and_b32 v3, 15, v2
    v_lshrrev_b32 v4, 4, v2
    s_mul_i32 s27, s34, 8192
    v_and_b32 v5, 7, v3
    v_xor_b32 v5, v5, v4
    v_lshlrev_b32 v5, 4, v5
    v_lshl_add_u32 v5, v3, 7, v5
    v_add_u32 v13, s27, v5
    v_xor_b32 v14, 64, v13
    v_lshrrev_b32 v5, 2, v3
    v_and_b32 v6, 3, v3
    v_and_b32 v7, 2, v5
    v_and_b32 v8, 1, v4
    v_lshl_add_u32 v7, v8, 2, v7
    v_lshl_add_u32 v8, v4, 3, v5
    v_lshlrev_b32 v8, 7, v8
    v_and_b32 v9, 1, v6
    v_lshl_add_u32 v8, v9, 3, v8
    v_add_u32 v8, 16384, v8
    v_lshrrev_b32 v9, 1, v6
    s_lshl_b32 s27, s35, 2
    v_add_u32 v15, 0, v9
    v_add_u32 v15, s27, v15
    v_xor_b32 v15, v15, v7
    v_lshl_add_u32 v15, v15, 4, v8
    v_add_u32 v16, 2, v9
    v_add_u32 v16, s27, v16
    v_xor_b32 v16, v16, v7
    v_lshl_add_u32 v16, v16, 4, v8
    v_mov_b32 v64, 0
    v_mov_b32 v65, 0
    v_mov_b32 v66, 0
    v_mov_b32 v67, 0
    v_mov_b32 v68, 0
    v_mov_b32 v69, 0
    v_mov_b32 v70, 0
    v_mov_b32 v71, 0
    v_mov_b32 v72, 0
    v_mov_b32 v73, 0
    v_mov_b32 v74, 0
    v_mov_b32 v75, 0
    v_mov_b32 v76, 0
    v_mov_b32 v77, 0
    v_mov_b32 v78, 0
    v_mov_b32 v79, 0
    v_mov_b32 v80, 0
    v_mov_b32 v81, 0
    v_mov_b32 v82, 0
    v_mov_b32 v83, 0
    v_mov_b32 v84, 0
    v_mov_b32 v85, 0
    v_mov_b32 v86, 0
    v_mov_b32 v87, 0
    v_mov_b32 v88, 0
    v_mov_b32 v89, 0
    v_mov_b32 v90, 0
    v_mov_b32 v91, 0
    v_mov_b32 v92, 0
    v_mov_b32 v93, 0
    v_mov_b32 v94, 0
    v_mov_b32 v95, 0
    v_mov_b32 v96, 0
    v_mov_b32 v97, 0
    v_mov_b32 v98, 0
    v_mov_b32 v99, 0
    v_mov_b32 v100, 0
    v_mov_b32 v101, 0
    v_mov_b32 v102, 0
    v_mov_b32 v103, 0
    v_mov_b32 v104, 0
    v_mov_b32 v105, 0
    v_mov_b32 v106, 0
    v_mov_b32 v107, 0
    v_mov_b32 v108, 0
    v_mov_b32 v109, 0
    v_mov_b32 v110, 0
    v_mov_b32 v111, 0
    v_mov_b32 v112, 0
    v_mov_b32 v113, 0
    v_mov_b32 v114, 0
    v_mov_b32 v115, 0
    v_mov_b32 v116, 0
    v_mov_b32 v117, 0
    v_mov_b32 v118, 0
    v_mov_b32 v119, 0
    v_mov_b32 v120, 0
    v_mov_b32 v121, 0
    v_mov_b32 v122, 0
    v_mov_b32 v123, 0
    v_mov_b32 v124, 0
    v_mov_b32 v125, 0
    v_mov_b32 v126, 0
    v_mov_b32 v127, 0
    s_mov_b32 s24, s31
    s_mov_b32 s25, 0
    s_mov_b32 s26, 10
    s_add_u32 m0, s38, 0
    s_add_u32 s27, s24, 0
    buffer_load_dwordx4 v10, s[8:11], s27 offen lds
    s_add_u32 m0, s38, 1024
    s_add_u32 s27, s24, 10240
    buffer_load_dwordx4 v10, s[8:11], s27 offen lds
    s_add_u32 m0, s38, 2048
    s_add_u32 s27, s24, 20480
    buffer_load_dwordx4 v10, s[8:11], s27 offen lds
    s_add_u32 m0, s38, 3072
    s_add_u32 s27, s24, 30720
    buffer_load_dwordx4 v10, s[8:11], s27 offen lds
    s_add_u32 m0, s39, 0
    s_add_u32 s27, s25, s32
    buffer_load_dwordx4 v11, s[12:15], s27 offen lds
    s_add_u32 m0, s39, 1024
    s_add_u32 s27, s25, s32
    buffer_load_dwordx4 v12, s[12:15], s27 offen lds
    s_add_u32 m0, s39, 8192
    s_add_u32 s27, s25, s33
    buffer_load_dwordx4 v11, s[16:19], s27 offen lds
    s_add_u32 m0, s39, 9216
    s_add_u32 s27, s25, s33
    buffer_load_dwordx4 v12, s[16:19], s27 offen lds
    s_add_u32 s24, s24, 128
    s_add_u32 s25, s25, s40
k1_loop:
    s_waitcnt vmcnt(0)
    s_barrier
    s_add_u32 m0, s38, 32768
    s_add_u32 s27, s24, 0
    buffer_load_dwordx4 v10, s[8:11], s27 offen lds
    s_add_u32 m0, s38, 33792
    s_add_u32 s27, s24, 10240
    buffer_load_dwordx4 v10, s[8:11], s27 offen lds
    s_add_u32 m0, s38, 34816
    s_add_u32 s27, s24, 20480
    buffer_load_dwordx4 v10, s[8:11], s27 offen lds
    s_add_u32 m0, s38, 35840
    s_add_u32 s27, s24, 30720
    buffer_load_dwordx4 v10, s[8:11], s27 offen lds
    s_add_u32 m0, s39, 32768
    s_add_u32 s27, s25, s32
    buffer_load_dwordx4 v11, s[12:15], s27 offen lds
    s_add_u32 m0, s39, 33792
    s_add_u32 s27, s25, s32
    buffer_load_dwordx4 v12, s[12:15], s27 offen lds
    s_add_u32 m0, s39, 40960
    s_add_u32 s27, s25, s33
    buffer_load_dwordx4 v11, s[16:19], s27 offen lds
    s_add_u32 m0, s39, 41984
    s_add_u32 s27, s25, s33
    buffer_load_dwordx4 v12, s[16:19], s27 offen lds
    s_add_u32 s24, s24, 128
    s_add_u32 s25, s25, s40
    ds_read_b128 v[128:131], v13 offset:0
    ds_read_b128 v[132:135], v13 offset:2048
    ds_read_b128 v[136:139], v13 offset:4096
    ds_read_b128 v[140:143], v13 offset:6144
    ds_read_b64_tr_b16 v[144:145], v15 offset:0
    ds_read_b64_tr_b16 v[146:147], v15 offset:512
    ds_read_b64_tr_b16 v[148:149], v16 offset:0
    ds_read_b64_tr_b16 v[150:151], v16 offset:512
    ds_read_b64_tr_b16 v[152:153], v15 offset:8192
    ds_read_b64_tr_b16 v[154:155], v15 offset:8704
    ds_read_b64_tr_b16 v[156:157], v16 offset:8192
    ds_read_b64_tr_b16 v[158:159], v16 offset:8704
    ds_read_b128 v[160:163], v14 offset:0
    ds_read_b128 v[164:167], v14 offset:2048
    ds_read_b128 v[168:171], v14 offset:4096
    ds_read_b128 v[172:175], v14 offset:6144
    ds_read_b64_tr_b16 v[176:177], v15 offset:4096
    ds_read_b64_tr_b16 v[178:179], v15 offset:4608
    ds_read_b64_tr_b16 v[180:181], v16 offset:4096
    ds_read_b64_tr_b16 v[182:183], v16 offset:4608
    ds_read_b64_tr_b16 v[184:185], v15 offset:12288
    ds_read_b64_tr_b16 v[186:187], v15 offset:12800
    ds_read_b64_tr_b16 v[188:189], v16 offset:12288
    ds_read_b64_tr_b16 v[190:191], v16 offset:12800
    s_waitcnt lgkmcnt(12)
    v_mfma_f32_16x16x32_bf16 v[64:67], v[144:147], v[128:131], v[64:67]
    v_mfma_f32_16x16x32_bf16 v[68:71], v[144:147], v[132:135], v[68:71]
    v_mfma_f32_16x16x32_bf16 v[72:75], v[144:147], v[136:139], v[72:75]
    v_mfma_f32_16x16x32_bf16 v[76:79], v[144:147], v[140:143], v[76:79]
    v_mfma_f32_16x16x32_bf16 v[80:83], v[148:151], v[128:131], v[80:83]
    v_mfma_f32_16x16x32_bf16 v[84:87], v[148:151], v[132:135], v[84:87]
    v_mfma_f32_16x16x32_bf16 v[88:91], v[148:151], v[136:139], v[88:91]
    v_mfma_f32_16x16x32_bf16 v[92:95], v[148:151], v[140:143], v[92:95]
    v_mfma_f32_16x16x32_bf16 v[96:99], v[152:155], v[128:131], v[96:99]
    v_mfma_f32_16x16x32_bf16 v[100:103], v[152:155], v[132:135], v[100:103]
    v_mfma_f32_16x16x32_bf16 v[104:107], v[152:155], v[136:139], v[104:107]
    v_mfma_f32_16x16x32_bf16 v[108:111], v[152:155], v[140:143], v[108:111]
    v_mfma_f32_16x16x32_bf16 v[112:115], v[156:159], v[128:131], v[112:115]
    v_mfma_f32_16x16x32_bf16 v[116:119], v[156:159], v[132:135], v[116:119]
    v_mfma_f32_16x16x32_bf16 v[120:123], v[156:159], v[136:139], v[120:123]
    v_mfma_f32_16x16x32_bf16 v[124:127], v[156:159], v[140:143], v[124:127]
    s_waitcnt lgkmcnt(0)
    v_mfma_f32_16x16x32_bf16 v[64:67], v[176:179], v[160:163], v[64:67]
    v_mfma_f32_16x16x32_bf16 v[68:71], v[176:179], v[164:167], v[68:71]
    v_mfma_f32_16x16x32_bf16 v[72:75], v[176:179], v[168:171], v[72:75]
    v_mfma_f32_16x16x32_bf16 v[76:79], v[176:179], v[172:175], v[76:79]
    v_mfma_f32_16x16x32_bf16 v[80:83], v[180:183], v[160:163], v[80:83]
    v_mfma_f32_16x16x32_bf16 v[84:87], v[180:183], v[164:167], v[84:87]
    v_mfma_f32_16x16x32_bf16 v[88:91], v[180:183], v[168:171], v[88:91]
    v_mfma_f32_16x16x32_bf16 v[92:95], v[180:183], v[172:175], v[92:95]
    v_mfma_f32_16x16x32_bf16 v[96:99], v[184:187], v[160:163], v[96:99]
    v_mfma_f32_16x16x32_bf16 v[100:103], v[184:187], v[164:167], v[100:103]
    v_mfma_f32_16x16x32_bf16 v[104:107], v[184:187], v[168:171], v[104:107]
    v_mfma_f32_16x16x32_bf16 v[108:111], v[184:187], v[172:175], v[108:111]
    v_mfma_f32_16x16x32_bf16 v[112:115], v[188:191], v[160:163], v[112:115]
    v_mfma_f32_16x16x32_bf16 v[116:119], v[188:191], v[164:167], v[116:119]
    v_mfma_f32_16x16x32_bf16 v[120:123], v[188:191], v[168:171], v[120:123]
    v_mfma_f32_16x16x32_bf16 v[124:127], v[188:191], v[172:175], v[124:127]
    s_sub_u32 s26, s26, 1
    s_cmp_eq_u32 s26, 0
    s_cbranch_scc1 k1_done
    s_waitcnt vmcnt(0)
    s_barrier
    s_add_u32 m0, s38, 0
    s_add_u32 s27, s24, 0
    buffer_load_dwordx4 v10, s[8:11], s27 offen lds
    s_add_u32 m0, s38, 1024
    s_add_u32 s27, s24, 10240
    buffer_load_dwordx4 v10, s[8:11], s27 offen lds
    s_add_u32 m0, s38, 2048
    s_add_u32 s27, s24, 20480
    buffer_load_dwordx4 v10, s[8:11], s27 offen lds
    s_add_u32 m0, s38, 3072
    s_add_u32 s27, s24, 30720
    buffer_load_dwordx4 v10, s[8:11], s27 offen lds
    s_add_u32 m0, s39, 0
    s_add_u32 s27, s25, s32
    buffer_load_dwordx4 v11, s[12:15], s27 offen lds
    s_add_u32 m0, s39, 1024
    s_add_u32 s27, s25, s32
    buffer_load_dwordx4 v12, s[12:15], s27 offen lds
    s_add_u32 m0, s39, 8192
    s_add_u32 s27, s25, s33
    buffer_load_dwordx4 v11, s[16:19], s27 offen lds
    s_add_u32 m0, s39, 9216
    s_add_u32 s27, s25, s33
    buffer_load_dwordx4 v12, s[16:19], s27 offen lds
    s_add_u32 s24, s24, 128
    s_add_u32 s25, s25, s40
    ds_read_b128 v[128:131], v13 offset:32768
    ds_read_b128 v[132:135], v13 offset:34816
    ds_read_b128 v[136:139], v13 offset:36864
    ds_read_b128 v[140:143], v13 offset:38912
    ds_read_b64_tr_b16 v[144:145], v15 offset:32768
    ds_read_b64_tr_b16 v[146:147], v15 offset:33280
    ds_read_b64_tr_b16 v[148:149], v16 offset:32768
    ds_read_b64_tr_b16 v[150:151], v16 offset:33280
    ds_read_b64_tr_b16 v[152:153], v15 offset:40960
    ds_read_b64_tr_b16 v[154:155], v15 offset:41472
    ds_read_b64_tr_b16 v[156:157], v16 offset:40960
    ds_read_b64_tr_b16 v[158:159], v16 offset:41472
    ds_read_b128 v[160:163], v14 offset:32768
    ds_read_b128 v[164:167], v14 offset:34816
    ds_read_b128 v[168:171], v14 offset:36864
    ds_read_b128 v[172:175], v14 offset:38912
    ds_read_b64_tr_b16 v[176:177], v15 offset:36864
    ds_read_b64_tr_b16 v[178:179], v15 offset:37376
    ds_read_b64_tr_b16 v[180:181], v16 offset:36864
    ds_read_b64_tr_b16 v[182:183], v16 offset:37376
    ds_read_b64_tr_b16 v[184:185], v15 offset:45056
    ds_read_b64_tr_b16 v[186:187], v15 offset:45568
    ds_read_b64_tr_b16 v[188:189], v16 offset:45056
    ds_read_b64_tr_b16 v[190:191], v16 offset:45568
    s_waitcnt lgkmcnt(12)
    v_mfma_f32_16x16x32_bf16 v[64:67], v[144:147], v[128:131], v[64:67]
    v_mfma_f32_16x16x32_bf16 v[68:71], v[144:147], v[132:135], v[68:71]
    v_mfma_f32_16x16x32_bf16 v[72:75], v[144:147], v[136:139], v[72:75]
    v_mfma_f32_16x16x32_bf16 v[76:79], v[144:147], v[140:143], v[76:79]
    v_mfma_f32_16x16x32_bf16 v[80:83], v[148:151], v[128:131], v[80:83]
    v_mfma_f32_16x16x32_bf16 v[84:87], v[148:151], v[132:135], v[84:87]
    v_mfma_f32_16x16x32_bf16 v[88:91], v[148:151], v[136:139], v[88:91]
    v_mfma_f32_16x16x32_bf16 v[92:95], v[148:151], v[140:143], v[92:95]
    v_mfma_f32_16x16x32_bf16 v[96:99], v[152:155], v[128:131], v[96:99]
    v_mfma_f32_16x16x32_bf16 v[100:103], v[152:155], v[132:135], v[100:103]
    v_mfma_f32_16x16x32_bf16 v[104:107], v[152:155], v[136:139], v[104:107]
    v_mfma_f32_16x16x32_bf16 v[108:111], v[152:155], v[140:143], v[108:111]
    v_mfma_f32_16x16x32_bf16 v[112:115], v[156:159], v[128:131], v[112:115]
    v_mfma_f32_16x16x32_bf16 v[116:119], v[156:159], v[132:135], v[116:119]
    v_mfma_f32_16x16x32_bf16 v[120:123], v[156:159], v[136:139], v[120:123]
    v_mfma_f32_16x16x32_bf16 v[124:127], v[156:159], v[140:143], v[124:127]
    s_waitcnt lgkmcnt(0)
    v_mfma_f32_16x16x32_bf16 v[64:67], v[176:179], v[160:163], v[64:67]
    v_mfma_f32_16x16x32_bf16 v[68:71], v[176:179], v[164:167], v[68:71]
    v_mfma_f32_16x16x32_bf16 v[72:75], v[176:179], v[168:171], v[72:75]
    v_mfma_f32_16x16x32_bf16 v[76:79], v[176:179], v[172:175], v[76:79]
    v_mfma_f32_16x16x32_bf16 v[80:83], v[180:183], v[160:163], v[80:83]
    v_mfma_f32_16x16x32_bf16 v[84:87], v[180:183], v[164:167], v[84:87]
    v_mfma_f32_16x16x32_bf16 v[88:91], v[180:183], v[168:171], v[88:91]
    v_mfma_f32_16x16x32_bf16 v[92:95], v[180:183], v[172:175], v[92:95]
    v_mfma_f32_16x16x32_bf16 v[96:99], v[184:187], v[160:163], v[96:99]
    v_mfma_f32_16x16x32_bf16 v[100:103], v[184:187], v[164:167], v[100:103]
    v_mfma_f32_16x16x32_bf16 v[104:107], v[184:187], v[168:171], v[104:107]
    v_mfma_f32_16x16x32_bf16 v[108:111], v[184:187], v[172:175], v[108:111]
    v_mfma_f32_16x16x32_bf16 v[112:115], v[188:191], v[160:163], v[112:115]
    v_mfma_f32_16x16x32_bf16 v[116:119], v[188:191], v[164:167], v[116:119]
    v_mfma_f32_16x16x32_bf16 v[120:123], v[188:191], v[168:171], v[120:123]
    v_mfma_f32_16x16x32_bf16 v[124:127], v[188:191], v[172:175], v[124:127]
    s_sub_u32 s26, s26, 1
    s_cmp_eq_u32 s26, 0
    s_cbranch_scc1 k1_done
    s_branch k1_loop
k1_done:
    s_nop 15
    s_lshl_b32 s27, s41, 7
    s_lshl_b32 s43, s34, 6
    s_add_u32 s27, s27, s43
    v_add_u32 v5, s27, v3
    s_cmp_ge_u32 s42, 15
    s_cbranch_scc1 k1_epf
    s_mul_i32 s27, s42, 13108
    s_lshr_b32 s27, s27, 16
    s_mul_i32 s43, s27, 5
    s_sub_u32 s43, s42, s43
    s_lshl_b32 s43, s43, 7
    s_mul_i32 s66, s27, 2621440
    s_lshl_b32 s27, s35, 5
    s_add_u32 s43, s43, s27
    v_mul_u32_u24 v5, 40, v5
    v_add_u32 v5, s66, v5
    s_movk_i32 s67, 3277
    v_lshlrev_b32 v6, 2, v4
    v_add_u32 v6, s43, v6
    v_add_u32 v6, 0, v6
    v_mul_lo_u32 v7, v6, s67
    v_lshrrev_b32 v7, 16, v7
    v_mul_u32_u24 v8, 20, v7
    v_sub_u32 v8, v6, v8
    v_mul_u32_u24 v7, 81920, v7
    v_lshl_add_u32 v7, v8, 1, v7
    v_add_u32 v7, v7, v5
    v_cvt_pk_bf16_f32 v128, v64, v65
    v_cvt_pk_bf16_f32 v129, v66, v67
    buffer_store_dwordx2 v[128:129], v7, s[20:23], 0 offen offset:0
    v_cvt_pk_bf16_f32 v130, v68, v69
    v_cvt_pk_bf16_f32 v131, v70, v71
    buffer_store_dwordx2 v[130:131], v7, s[20:23], 0 offen offset:640
    v_cvt_pk_bf16_f32 v132, v72, v73
    v_cvt_pk_bf16_f32 v133, v74, v75
    buffer_store_dwordx2 v[132:133], v7, s[20:23], 0 offen offset:1280
    v_cvt_pk_bf16_f32 v134, v76, v77
    v_cvt_pk_bf16_f32 v135, v78, v79
    buffer_store_dwordx2 v[134:135], v7, s[20:23], 0 offen offset:1920
    v_lshlrev_b32 v6, 2, v4
    v_add_u32 v6, s43, v6
    v_add_u32 v6, 16, v6
    v_mul_lo_u32 v7, v6, s67
    v_lshrrev_b32 v7, 16, v7
    v_mul_u32_u24 v8, 20, v7
    v_sub_u32 v8, v6, v8
    v_mul_u32_u24 v7, 81920, v7
    v_lshl_add_u32 v7, v8, 1, v7
    v_add_u32 v7, v7, v5
    v_cvt_pk_bf16_f32 v136, v80, v81
    v_cvt_pk_bf16_f32 v137, v82, v83
    buffer_store_dwordx2 v[136:137], v7, s[20:23], 0 offen offset:0
    v_cvt_pk_bf16_f32 v138, v84, v85
    v_cvt_pk_bf16_f32 v139, v86, v87
    buffer_store_dwordx2 v[138:139], v7, s[20:23], 0 offen offset:640
    v_cvt_pk_bf16_f32 v140, v88, v89
    v_cvt_pk_bf16_f32 v141, v90, v91
    buffer_store_dwordx2 v[140:141], v7, s[20:23], 0 offen offset:1280
    v_cvt_pk_bf16_f32 v142, v92, v93
    v_cvt_pk_bf16_f32 v143, v94, v95
    buffer_store_dwordx2 v[142:143], v7, s[20:23], 0 offen offset:1920
    v_lshlrev_b32 v6, 2, v4
    v_add_u32 v6, s43, v6
    v_add_u32 v6, 64, v6
    v_mul_lo_u32 v7, v6, s67
    v_lshrrev_b32 v7, 16, v7
    v_mul_u32_u24 v8, 20, v7
    v_sub_u32 v8, v6, v8
    v_mul_u32_u24 v7, 81920, v7
    v_lshl_add_u32 v7, v8, 1, v7
    v_add_u32 v7, v7, v5
    v_cvt_pk_bf16_f32 v144, v96, v97
    v_cvt_pk_bf16_f32 v145, v98, v99
    buffer_store_dwordx2 v[144:145], v7, s[20:23], 0 offen offset:0
    v_cvt_pk_bf16_f32 v146, v100, v101
    v_cvt_pk_bf16_f32 v147, v102, v103
    buffer_store_dwordx2 v[146:147], v7, s[20:23], 0 offen offset:640
    v_cvt_pk_bf16_f32 v148, v104, v105
    v_cvt_pk_bf16_f32 v149, v106, v107
    buffer_store_dwordx2 v[148:149], v7, s[20:23], 0 offen offset:1280
    v_cvt_pk_bf16_f32 v150, v108, v109
    v_cvt_pk_bf16_f32 v151, v110, v111
    buffer_store_dwordx2 v[150:151], v7, s[20:23], 0 offen offset:1920
    v_lshlrev_b32 v6, 2, v4
    v_add_u32 v6, s43, v6
    v_add_u32 v6, 80, v6
    v_mul_lo_u32 v7, v6, s67
    v_lshrrev_b32 v7, 16, v7
    v_mul_u32_u24 v8, 20, v7
    v_sub_u32 v8, v6, v8
    v_mul_u32_u24 v7, 81920, v7
    v_lshl_add_u32 v7, v8, 1, v7
    v_add_u32 v7, v7, v5
    v_cvt_pk_bf16_f32 v152, v112, v113
    v_cvt_pk_bf16_f32 v153, v114, v115
    buffer_store_dwordx2 v[152:153], v7, s[20:23], 0 offen offset:0
    v_cvt_pk_bf16_f32 v154, v116, v117
    v_cvt_pk_bf16_f32 v155, v118, v119
    buffer_store_dwordx2 v[154:155], v7, s[20:23], 0 offen offset:640
    v_cvt_pk_bf16_f32 v156, v120, v121
    v_cvt_pk_bf16_f32 v157, v122, v123
    buffer_store_dwordx2 v[156:157], v7, s[20:23], 0 offen offset:1280
    v_cvt_pk_bf16_f32 v158, v124, v125
    v_cvt_pk_bf16_f32 v159, v126, v127
    buffer_store_dwordx2 v[158:159], v7, s[20:23], 0 offen offset:1920
    s_branch k1_end
k1_epf:
    s_movk_i32 s67, 3456
    v_mul_lo_u32 v5, v5, s67
    v_lshl_add_u32 v5, v4, 3, v5
    s_lshl_b32 s27, s35, 6
    s_add_u32 s27, s27, s32
    s_add_u32 s27, s27, 7864320
    v_add_u32 v5, s27, v5
    s_mov_b32 s67, 0xbfb8aa3b
    v_cvt_pk_bf16_f32 v20, v64, v65
    v_cvt_pk_bf16_f32 v21, v66, v67
    v_cvt_pk_bf16_f32 v22, v96, v97
    v_cvt_pk_bf16_f32 v23, v98, v99
    v_lshlrev_b32 v24, 16, v20
    v_and_b32 v25, 0xffff0000, v20
    v_lshlrev_b32 v26, 16, v21
    v_and_b32 v27, 0xffff0000, v21
    v_lshlrev_b32 v28, 16, v22
    v_and_b32 v29, 0xffff0000, v22
    v_lshlrev_b32 v30, 16, v23
    v_and_b32 v31, 0xffff0000, v23
    v_mul_f32 v32, s67, v24
    v_mul_f32 v33, s67, v25
    v_mul_f32 v34, s67, v26
    v_mul_f32 v35, s67, v27
    v_exp_f32 v32, v32
    v_exp_f32 v33, v33
    v_exp_f32 v34, v34
    v_exp_f32 v35, v35
    v_add_f32 v32, 1.0, v32
    v_add_f32 v33, 1.0, v33
    v_add_f32 v34, 1.0, v34
    v_add_f32 v35, 1.0, v35
    v_rcp_f32 v32, v32
    v_rcp_f32 v33, v33
    v_rcp_f32 v34, v34
    v_rcp_f32 v35, v35
    s_nop 0
    v_mul_f32 v24, v24, v32
    v_mul_f32 v25, v25, v33
    v_mul_f32 v26, v26, v34
    v_mul_f32 v27, v27, v35
    v_cvt_pk_bf16_f32 v20, v24, v25
    v_cvt_pk_bf16_f32 v21, v26, v27
    v_lshlrev_b32 v24, 16, v20
    v_and_b32 v25, 0xffff0000, v20
    v_lshlrev_b32 v26, 16, v21
    v_and_b32 v27, 0xffff0000, v21
    v_mul_f32 v24, v24, v28
    v_mul_f32 v25, v25, v29
    v_mul_f32 v26, v26, v30
    v_mul_f32 v27, v27, v31
    v_cvt_pk_bf16_f32 v128, v24, v25
    v_cvt_pk_bf16_f32 v129, v26, v27
    s_mov_b32 s27, 0
    buffer_store_dwordx2 v[128:129], v5, s[20:23], s27 offen
    v_cvt_pk_bf16_f32 v20, v68, v69
    v_cvt_pk_bf16_f32 v21, v70, v71
    v_cvt_pk_bf16_f32 v22, v100, v101
    v_cvt_pk_bf16_f32 v23, v102, v103
    v_lshlrev_b32 v24, 16, v20
    v_and_b32 v25, 0xffff0000, v20
    v_lshlrev_b32 v26, 16, v21
    v_and_b32 v27, 0xffff0000, v21
    v_lshlrev_b32 v28, 16, v22
    v_and_b32 v29, 0xffff0000, v22
    v_lshlrev_b32 v30, 16, v23
    v_and_b32 v31, 0xffff0000, v23
    v_mul_f32 v32, s67, v24
    v_mul_f32 v33, s67, v25
    v_mul_f32 v34, s67, v26
    v_mul_f32 v35, s67, v27
    v_exp_f32 v32, v32
    v_exp_f32 v33, v33
    v_exp_f32 v34, v34
    v_exp_f32 v35, v35
    v_add_f32 v32, 1.0, v32
    v_add_f32 v33, 1.0, v33
    v_add_f32 v34, 1.0, v34
    v_add_f32 v35, 1.0, v35
    v_rcp_f32 v32, v32
    v_rcp_f32 v33, v33
    v_rcp_f32 v34, v34
    v_rcp_f32 v35, v35
    s_nop 0
    v_mul_f32 v24, v24, v32
    v_mul_f32 v25, v25, v33
    v_mul_f32 v26, v26, v34
    v_mul_f32 v27, v27, v35
    v_cvt_pk_bf16_f32 v20, v24, v25
    v_cvt_pk_bf16_f32 v21, v26, v27
    v_lshlrev_b32 v24, 16, v20
    v_and_b32 v25, 0xffff0000, v20
    v_lshlrev_b32 v26, 16, v21
    v_and_b32 v27, 0xffff0000, v21
    v_mul_f32 v24, v24, v28
    v_mul_f32 v25, v25, v29
    v_mul_f32 v26, v26, v30
    v_mul_f32 v27, v27, v31
    v_cvt_pk_bf16_f32 v130, v24, v25
    v_cvt_pk_bf16_f32 v131, v26, v27
    s_mov_b32 s27, 55296
    buffer_store_dwordx2 v[130:131], v5, s[20:23], s27 offen
    v_cvt_pk_bf16_f32 v20, v72, v73
    v_cvt_pk_bf16_f32 v21, v74, v75
    v_cvt_pk_bf16_f32 v22, v104, v105
    v_cvt_pk_bf16_f32 v23, v106, v107
    v_lshlrev_b32 v24, 16, v20
    v_and_b32 v25, 0xffff0000, v20
    v_lshlrev_b32 v26, 16, v21
    v_and_b32 v27, 0xffff0000, v21
    v_lshlrev_b32 v28, 16, v22
    v_and_b32 v29, 0xffff0000, v22
    v_lshlrev_b32 v30, 16, v23
    v_and_b32 v31, 0xffff0000, v23
    v_mul_f32 v32, s67, v24
    v_mul_f32 v33, s67, v25
    v_mul_f32 v34, s67, v26
    v_mul_f32 v35, s67, v27
    v_exp_f32 v32, v32
    v_exp_f32 v33, v33
    v_exp_f32 v34, v34
    v_exp_f32 v35, v35
    v_add_f32 v32, 1.0, v32
    v_add_f32 v33, 1.0, v33
    v_add_f32 v34, 1.0, v34
    v_add_f32 v35, 1.0, v35
    v_rcp_f32 v32, v32
    v_rcp_f32 v33, v33
    v_rcp_f32 v34, v34
    v_rcp_f32 v35, v35
    s_nop 0
    v_mul_f32 v24, v24, v32
    v_mul_f32 v25, v25, v33
    v_mul_f32 v26, v26, v34
    v_mul_f32 v27, v27, v35
    v_cvt_pk_bf16_f32 v20, v24, v25
    v_cvt_pk_bf16_f32 v21, v26, v27
    v_lshlrev_b32 v24, 16, v20
    v_and_b32 v25, 0xffff0000, v20
    v_lshlrev_b32 v26, 16, v21
    v_and_b32 v27, 0xffff0000, v21
    v_mul_f32 v24, v24, v28
    v_mul_f32 v25, v25, v29
    v_mul_f32 v26, v26, v30
    v_mul_f32 v27, v27, v31
    v_cvt_pk_bf16_f32 v132, v24, v25
    v_cvt_pk_bf16_f32 v133, v26, v27
    s_mov_b32 s27, 110592
    buffer_store_dwordx2 v[132:133], v5, s[20:23], s27 offen
    v_cvt_pk_bf16_f32 v20, v76, v77
    v_cvt_pk_bf16_f32 v21, v78, v79
    v_cvt_pk_bf16_f32 v22, v108, v109
    v_cvt_pk_bf16_f32 v23, v110, v111
    v_lshlrev_b32 v24, 16, v20
    v_and_b32 v25, 0xffff0000, v20
    v_lshlrev_b32 v26, 16, v21
    v_and_b32 v27, 0xffff0000, v21
    v_lshlrev_b32 v28, 16, v22
    v_and_b32 v29, 0xffff0000, v22
    v_lshlrev_b32 v30, 16, v23
    v_and_b32 v31, 0xffff0000, v23
    v_mul_f32 v32, s67, v24
    v_mul_f32 v33, s67, v25
    v_mul_f32 v34, s67, v26
    v_mul_f32 v35, s67, v27
    v_exp_f32 v32, v32
    v_exp_f32 v33, v33
    v_exp_f32 v34, v34
    v_exp_f32 v35, v35
    v_add_f32 v32, 1.0, v32
    v_add_f32 v33, 1.0, v33
    v_add_f32 v34, 1.0, v34
    v_add_f32 v35, 1.0, v35
    v_rcp_f32 v32, v32
    v_rcp_f32 v33, v33
    v_rcp_f32 v34, v34
    v_rcp_f32 v35, v35
    s_nop 0
    v_mul_f32 v24, v24, v32
    v_mul_f32 v25, v25, v33
    v_mul_f32 v26, v26, v34
    v_mul_f32 v27, v27, v35
    v_cvt_pk_bf16_f32 v20, v24, v25
    v_cvt_pk_bf16_f32 v21, v26, v27
    v_lshlrev_b32 v24, 16, v20
    v_and_b32 v25, 0xffff0000, v20
    v_lshlrev_b32 v26, 16, v21
    v_and_b32 v27, 0xffff0000, v21
    v_mul_f32 v24, v24, v28
    v_mul_f32 v25, v25, v29
    v_mul_f32 v26, v26, v30
    v_mul_f32 v27, v27, v31
    v_cvt_pk_bf16_f32 v134, v24, v25
    v_cvt_pk_bf16_f32 v135, v26, v27
    s_mov_b32 s27, 165888
    buffer_store_dwordx2 v[134:135], v5, s[20:23], s27 offen
    v_cvt_pk_bf16_f32 v20, v80, v81
    v_cvt_pk_bf16_f32 v21, v82, v83
    v_cvt_pk_bf16_f32 v22, v112, v113
    v_cvt_pk_bf16_f32 v23, v114, v115
    v_lshlrev_b32 v24, 16, v20
    v_and_b32 v25, 0xffff0000, v20
    v_lshlrev_b32 v26, 16, v21
    v_and_b32 v27, 0xffff0000, v21
    v_lshlrev_b32 v28, 16, v22
    v_and_b32 v29, 0xffff0000, v22
    v_lshlrev_b32 v30, 16, v23
    v_and_b32 v31, 0xffff0000, v23
    v_mul_f32 v32, s67, v24
    v_mul_f32 v33, s67, v25
    v_mul_f32 v34, s67, v26
    v_mul_f32 v35, s67, v27
    v_exp_f32 v32, v32
    v_exp_f32 v33, v33
    v_exp_f32 v34, v34
    v_exp_f32 v35, v35
    v_add_f32 v32, 1.0, v32
    v_add_f32 v33, 1.0, v33
    v_add_f32 v34, 1.0, v34
    v_add_f32 v35, 1.0, v35
    v_rcp_f32 v32, v32
    v_rcp_f32 v33, v33
    v_rcp_f32 v34, v34
    v_rcp_f32 v35, v35
    s_nop 0
    v_mul_f32 v24, v24, v32
    v_mul_f32 v25, v25, v33
    v_mul_f32 v26, v26, v34
    v_mul_f32 v27, v27, v35
    v_cvt_pk_bf16_f32 v20, v24, v25
    v_cvt_pk_bf16_f32 v21, v26, v27
    v_lshlrev_b32 v24, 16, v20
    v_and_b32 v25, 0xffff0000, v20
    v_lshlrev_b32 v26, 16, v21
    v_and_b32 v27, 0xffff0000, v21
    v_mul_f32 v24, v24, v28
    v_mul_f32 v25, v25, v29
    v_mul_f32 v26, v26, v30
    v_mul_f32 v27, v27, v31
    v_cvt_pk_bf16_f32 v136, v24, v25
    v_cvt_pk_bf16_f32 v137, v26, v27
    s_mov_b32 s27, 32
    buffer_store_dwordx2 v[136:137], v5, s[20:23], s27 offen
    v_cvt_pk_bf16_f32 v20, v84, v85
    v_cvt_pk_bf16_f32 v21, v86, v87
    v_cvt_pk_bf16_f32 v22, v116, v117
    v_cvt_pk_bf16_f32 v23, v118, v119
    v_lshlrev_b32 v24, 16, v20
    v_and_b32 v25, 0xffff0000, v20
    v_lshlrev_b32 v26, 16, v21
    v_and_b32 v27, 0xffff0000, v21
    v_lshlrev_b32 v28, 16, v22
    v_and_b32 v29, 0xffff0000, v22
    v_lshlrev_b32 v30, 16, v23
    v_and_b32 v31, 0xffff0000, v23
    v_mul_f32 v32, s67, v24
    v_mul_f32 v33, s67, v25
    v_mul_f32 v34, s67, v26
    v_mul_f32 v35, s67, v27
    v_exp_f32 v32, v32
    v_exp_f32 v33, v33
    v_exp_f32 v34, v34
    v_exp_f32 v35, v35
    v_add_f32 v32, 1.0, v32
    v_add_f32 v33, 1.0, v33
    v_add_f32 v34, 1.0, v34
    v_add_f32 v35, 1.0, v35
    v_rcp_f32 v32, v32
    v_rcp_f32 v33, v33
    v_rcp_f32 v34, v34
    v_rcp_f32 v35, v35
    s_nop 0
    v_mul_f32 v24, v24, v32
    v_mul_f32 v25, v25, v33
    v_mul_f32 v26, v26, v34
    v_mul_f32 v27, v27, v35
    v_cvt_pk_bf16_f32 v20, v24, v25
    v_cvt_pk_bf16_f32 v21, v26, v27
    v_lshlrev_b32 v24, 16, v20
    v_and_b32 v25, 0xffff0000, v20
    v_lshlrev_b32 v26, 16, v21
    v_and_b32 v27, 0xffff0000, v21
    v_mul_f32 v24, v24, v28
    v_mul_f32 v25, v25, v29
    v_mul_f32 v26, v26, v30
    v_mul_f32 v27, v27, v31
    v_cvt_pk_bf16_f32 v138, v24, v25
    v_cvt_pk_bf16_f32 v139, v26, v27
    s_mov_b32 s27, 55328
    buffer_store_dwordx2 v[138:139], v5, s[20:23], s27 offen
    v_cvt_pk_bf16_f32 v20, v88, v89
    v_cvt_pk_bf16_f32 v21, v90, v91
    v_cvt_pk_bf16_f32 v22, v120, v121
    v_cvt_pk_bf16_f32 v23, v122, v123
    v_lshlrev_b32 v24, 16, v20
    v_and_b32 v25, 0xffff0000, v20
    v_lshlrev_b32 v26, 16, v21
    v_and_b32 v27, 0xffff0000, v21
    v_lshlrev_b32 v28, 16, v22
    v_and_b32 v29, 0xffff0000, v22
    v_lshlrev_b32 v30, 16, v23
    v_and_b32 v31, 0xffff0000, v23
    v_mul_f32 v32, s67, v24
    v_mul_f32 v33, s67, v25
    v_mul_f32 v34, s67, v26
    v_mul_f32 v35, s67, v27
    v_exp_f32 v32, v32
    v_exp_f32 v33, v33
    v_exp_f32 v34, v34
    v_exp_f32 v35, v35
    v_add_f32 v32, 1.0, v32
    v_add_f32 v33, 1.0, v33
    v_add_f32 v34, 1.0, v34
    v_add_f32 v35, 1.0, v35
    v_rcp_f32 v32, v32
    v_rcp_f32 v33, v33
    v_rcp_f32 v34, v34
    v_rcp_f32 v35, v35
    s_nop 0
    v_mul_f32 v24, v24, v32
    v_mul_f32 v25, v25, v33
    v_mul_f32 v26, v26, v34
    v_mul_f32 v27, v27, v35
    v_cvt_pk_bf16_f32 v20, v24, v25
    v_cvt_pk_bf16_f32 v21, v26, v27
    v_lshlrev_b32 v24, 16, v20
    v_and_b32 v25, 0xffff0000, v20
    v_lshlrev_b32 v26, 16, v21
    v_and_b32 v27, 0xffff0000, v21
    v_mul_f32 v24, v24, v28
    v_mul_f32 v25, v25, v29
    v_mul_f32 v26, v26, v30
    v_mul_f32 v27, v27, v31
    v_cvt_pk_bf16_f32 v140, v24, v25
    v_cvt_pk_bf16_f32 v141, v26, v27
    s_mov_b32 s27, 110624
    buffer_store_dwordx2 v[140:141], v5, s[20:23], s27 offen
    v_cvt_pk_bf16_f32 v20, v92, v93
    v_cvt_pk_bf16_f32 v21, v94, v95
    v_cvt_pk_bf16_f32 v22, v124, v125
    v_cvt_pk_bf16_f32 v23, v126, v127
    v_lshlrev_b32 v24, 16, v20
    v_and_b32 v25, 0xffff0000, v20
    v_lshlrev_b32 v26, 16, v21
    v_and_b32 v27, 0xffff0000, v21
    v_lshlrev_b32 v28, 16, v22
    v_and_b32 v29, 0xffff0000, v22
    v_lshlrev_b32 v30, 16, v23
    v_and_b32 v31, 0xffff0000, v23
    v_mul_f32 v32, s67, v24
    v_mul_f32 v33, s67, v25
    v_mul_f32 v34, s67, v26
    v_mul_f32 v35, s67, v27
    v_exp_f32 v32, v32
    v_exp_f32 v33, v33
    v_exp_f32 v34, v34
    v_exp_f32 v35, v35
    v_add_f32 v32, 1.0, v32
    v_add_f32 v33, 1.0, v33
    v_add_f32 v34, 1.0, v34
    v_add_f32 v35, 1.0, v35
    v_rcp_f32 v32, v32
    v_rcp_f32 v33, v33
    v_rcp_f32 v34, v34
    v_rcp_f32 v35, v35
    s_nop 0
    v_mul_f32 v24, v24, v32
    v_mul_f32 v25, v25, v33
    v_mul_f32 v26, v26, v34
    v_mul_f32 v27, v27, v35
    v_cvt_pk_bf16_f32 v20, v24, v25
    v_cvt_pk_bf16_f32 v21, v26, v27
    v_lshlrev_b32 v24, 16, v20
    v_and_b32 v25, 0xffff0000, v20
    v_lshlrev_b32 v26, 16, v21
    v_and_b32 v27, 0xffff0000, v21
    v_mul_f32 v24, v24, v28
    v_mul_f32 v25, v25, v29
    v_mul_f32 v26, v26, v30
    v_mul_f32 v27, v27, v31
    v_cvt_pk_bf16_f32 v142, v24, v25
    v_cvt_pk_bf16_f32 v143, v26, v27
    s_mov_b32 s27, 165920
    buffer_store_dwordx2 v[142:143], v5, s[20:23], s27 offen
    s_branch k1_end
k1_g:
    s_mov_b32 s8, s44
    s_and_b32 s9, s45, 0xffff
    s_mov_b32 s10, 2621440
    s_mov_b32 s11, 0x20000
    s_mov_b32 s12, s58
    s_and_b32 s13, s59, 0xffff
    s_mov_b32 s14, 1280
    s_mov_b32 s15, 0x20000
    s_lshl_b32 s27, s2, 6
    v_lshrrev_b32 v1, 2, v0
    v_add_u32 v1, s27, v1
    v_and_b32 v2, 3, v0
    v_mul_u32_u24 v3, 320, v2
    v_mul_u32_u24 v4, 1280, v1
    v_add_u32 v4, v4, v3
    v_mov_b32 v5, 0
    buffer_load_dwordx4 v[32:35], v4, s[8:11], 0 offen offset:0
    buffer_load_dwordx4 v[36:39], v3, s[12:15], 0 offen offset:0
    buffer_load_dwordx4 v[40:43], v4, s[8:11], 0 offen offset:16
    buffer_load_dwordx4 v[44:47], v3, s[12:15], 0 offen offset:16
    buffer_load_dwordx4 v[48:51], v4, s[8:11], 0 offen offset:32
    buffer_load_dwordx4 v[52:55], v3, s[12:15], 0 offen offset:32
    buffer_load_dwordx4 v[56:59], v4, s[8:11], 0 offen offset:48
    buffer_load_dwordx4 v[60:63], v3, s[12:15], 0 offen offset:48
    buffer_load_dwordx4 v[64:67], v4, s[8:11], 0 offen offset:64
    buffer_load_dwordx4 v[68:71], v3, s[12:15], 0 offen offset:64
    buffer_load_dwordx4 v[72:75], v4, s[8:11], 0 offen offset:80
    buffer_load_dwordx4 v[76:79], v3, s[12:15], 0 offen offset:80
    buffer_load_dwordx4 v[80:83], v4, s[8:11], 0 offen offset:96
    buffer_load_dwordx4 v[84:87], v3, s[12:15], 0 offen offset:96
    buffer_load_dwordx4 v[88:91], v4, s[8:11], 0 offen offset:112
    buffer_load_dwordx4 v[92:95], v3, s[12:15], 0 offen offset:112
    buffer_load_dwordx4 v[96:99], v4, s[8:11], 0 offen offset:128
    buffer_load_dwordx4 v[100:103], v3, s[12:15], 0 offen offset:128
    buffer_load_dwordx4 v[104:107], v4, s[8:11], 0 offen offset:144
    buffer_load_dwordx4 v[108:111], v3, s[12:15], 0 offen offset:144
    buffer_load_dwordx4 v[112:115], v4, s[8:11], 0 offen offset:160
    buffer_load_dwordx4 v[116:119], v3, s[12:15], 0 offen offset:160
    buffer_load_dwordx4 v[120:123], v4, s[8:11], 0 offen offset:176
    buffer_load_dwordx4 v[124:127], v3, s[12:15], 0 offen offset:176
    buffer_load_dwordx4 v[128:131], v4, s[8:11], 0 offen offset:192
    buffer_load_dwordx4 v[132:135], v3, s[12:15], 0 offen offset:192
    buffer_load_dwordx4 v[136:139], v4, s[8:11], 0 offen offset:208
    buffer_load_dwordx4 v[140:143], v3, s[12:15], 0 offen offset:208
    buffer_load_dwordx4 v[144:147], v4, s[8:11], 0 offen offset:224
    buffer_load_dwordx4 v[148:151], v3, s[12:15], 0 offen offset:224
    buffer_load_dwordx4 v[152:155], v4, s[8:11], 0 offen offset:240
    buffer_load_dwordx4 v[156:159], v3, s[12:15], 0 offen offset:240
    buffer_load_dwordx4 v[160:163], v4, s[8:11], 0 offen offset:256
    buffer_load_dwordx4 v[164:167], v3, s[12:15], 0 offen offset:256
    buffer_load_dwordx4 v[168:171], v4, s[8:11], 0 offen offset:272
    buffer_load_dwordx4 v[172:175], v3, s[12:15], 0 offen offset:272
    buffer_load_dwordx4 v[176:179], v4, s[8:11], 0 offen offset:288
    buffer_load_dwordx4 v[180:183], v3, s[12:15], 0 offen offset:288
    buffer_load_dwordx4 v[184:187], v4, s[8:11], 0 offen offset:304
    buffer_load_dwordx4 v[188:191], v3, s[12:15], 0 offen offset:304
    s_waitcnt vmcnt(38)
    v_lshlrev_b32 v16, 16, v32
    v_and_b32 v17, 0xffff0000, v32
    v_lshlrev_b32 v18, 16, v33
    v_and_b32 v19, 0xffff0000, v33
    v_lshlrev_b32 v20, 16, v36
    v_and_b32 v21, 0xffff0000, v36
    v_lshlrev_b32 v22, 16, v37
    v_and_b32 v23, 0xffff0000, v37
    v_mul_f32 v16, v16, v20
    v_mul_f32 v17, v17, v21
    v_mul_f32 v18, v18, v22
    v_mul_f32 v19, v19, v23
    v_cvt_pk_bf16_f32 v24, v16, v17
    v_cvt_pk_bf16_f32 v25, v18, v19
    v_lshlrev_b32 v16, 16, v24
    v_and_b32 v17, 0xffff0000, v24
    v_lshlrev_b32 v18, 16, v25
    v_and_b32 v19, 0xffff0000, v25
    v_add_f32 v5, v5, v16
    v_add_f32 v5, v5, v17
    v_add_f32 v5, v5, v18
    v_add_f32 v5, v5, v19
    v_lshlrev_b32 v16, 16, v34
    v_and_b32 v17, 0xffff0000, v34
    v_lshlrev_b32 v18, 16, v35
    v_and_b32 v19, 0xffff0000, v35
    v_lshlrev_b32 v20, 16, v38
    v_and_b32 v21, 0xffff0000, v38
    v_lshlrev_b32 v22, 16, v39
    v_and_b32 v23, 0xffff0000, v39
    v_mul_f32 v16, v16, v20
    v_mul_f32 v17, v17, v21
    v_mul_f32 v18, v18, v22
    v_mul_f32 v19, v19, v23
    v_cvt_pk_bf16_f32 v24, v16, v17
    v_cvt_pk_bf16_f32 v25, v18, v19
    v_lshlrev_b32 v16, 16, v24
    v_and_b32 v17, 0xffff0000, v24
    v_lshlrev_b32 v18, 16, v25
    v_and_b32 v19, 0xffff0000, v25
    v_add_f32 v5, v5, v16
    v_add_f32 v5, v5, v17
    v_add_f32 v5, v5, v18
    v_add_f32 v5, v5, v19
    s_waitcnt vmcnt(36)
    v_lshlrev_b32 v16, 16, v40
    v_and_b32 v17, 0xffff0000, v40
    v_lshlrev_b32 v18, 16, v41
    v_and_b32 v19, 0xffff0000, v41
    v_lshlrev_b32 v20, 16, v44
    v_and_b32 v21, 0xffff0000, v44
    v_lshlrev_b32 v22, 16, v45
    v_and_b32 v23, 0xffff0000, v45
    v_mul_f32 v16, v16, v20
    v_mul_f32 v17, v17, v21
    v_mul_f32 v18, v18, v22
    v_mul_f32 v19, v19, v23
    v_cvt_pk_bf16_f32 v24, v16, v17
    v_cvt_pk_bf16_f32 v25, v18, v19
    v_lshlrev_b32 v16, 16, v24
    v_and_b32 v17, 0xffff0000, v24
    v_lshlrev_b32 v18, 16, v25
    v_and_b32 v19, 0xffff0000, v25
    v_add_f32 v5, v5, v16
    v_add_f32 v5, v5, v17
    v_add_f32 v5, v5, v18
    v_add_f32 v5, v5, v19
    v_lshlrev_b32 v16, 16, v42
    v_and_b32 v17, 0xffff0000, v42
    v_lshlrev_b32 v18, 16, v43
    v_and_b32 v19, 0xffff0000, v43
    v_lshlrev_b32 v20, 16, v46
    v_and_b32 v21, 0xffff0000, v46
    v_lshlrev_b32 v22, 16, v47
    v_and_b32 v23, 0xffff0000, v47
    v_mul_f32 v16, v16, v20
    v_mul_f32 v17, v17, v21
    v_mul_f32 v18, v18, v22
    v_mul_f32 v19, v19, v23
    v_cvt_pk_bf16_f32 v24, v16, v17
    v_cvt_pk_bf16_f32 v25, v18, v19
    v_lshlrev_b32 v16, 16, v24
    v_and_b32 v17, 0xffff0000, v24
    v_lshlrev_b32 v18, 16, v25
    v_and_b32 v19, 0xffff0000, v25
    v_add_f32 v5, v5, v16
    v_add_f32 v5, v5, v17
    v_add_f32 v5, v5, v18
    v_add_f32 v5, v5, v19
    s_waitcnt vmcnt(34)
    v_lshlrev_b32 v16, 16, v48
    v_and_b32 v17, 0xffff0000, v48
    v_lshlrev_b32 v18, 16, v49
    v_and_b32 v19, 0xffff0000, v49
    v_lshlrev_b32 v20, 16, v52
    v_and_b32 v21, 0xffff0000, v52
    v_lshlrev_b32 v22, 16, v53
    v_and_b32 v23, 0xffff0000, v53
    v_mul_f32 v16, v16, v20
    v_mul_f32 v17, v17, v21
    v_mul_f32 v18, v18, v22
    v_mul_f32 v19, v19, v23
    v_cvt_pk_bf16_f32 v24, v16, v17
    v_cvt_pk_bf16_f32 v25, v18, v19
    v_lshlrev_b32 v16, 16, v24
    v_and_b32 v17, 0xffff0000, v24
    v_lshlrev_b32 v18, 16, v25
    v_and_b32 v19, 0xffff0000, v25
    v_add_f32 v5, v5, v16
    v_add_f32 v5, v5, v17
    v_add_f32 v5, v5, v18
    v_add_f32 v5, v5, v19
    v_lshlrev_b32 v16, 16, v50
    v_and_b32 v17, 0xffff0000, v50
    v_lshlrev_b32 v18, 16, v51
    v_and_b32 v19, 0xffff0000, v51
    v_lshlrev_b32 v20, 16, v54
    v_and_b32 v21, 0xffff0000, v54
    v_lshlrev_b32 v22, 16, v55
    v_and_b32 v23, 0xffff0000, v55
    v_mul_f32 v16, v16, v20
    v_mul_f32 v17, v17, v21
    v_mul_f32 v18, v18, v22
    v_mul_f32 v19, v19, v23
    v_cvt_pk_bf16_f32 v24, v16, v17
    v_cvt_pk_bf16_f32 v25, v18, v19
    v_lshlrev_b32 v16, 16, v24
    v_and_b32 v17, 0xffff0000, v24
    v_lshlrev_b32 v18, 16, v25
    v_and_b32 v19, 0xffff0000, v25
    v_add_f32 v5, v5, v16
    v_add_f32 v5, v5, v17
    v_add_f32 v5, v5, v18
    v_add_f32 v5, v5, v19
    s_waitcnt vmcnt(32)
    v_lshlrev_b32 v16, 16, v56
    v_and_b32 v17, 0xffff0000, v56
    v_lshlrev_b32 v18, 16, v57
    v_and_b32 v19, 0xffff0000, v57
    v_lshlrev_b32 v20, 16, v60
    v_and_b32 v21, 0xffff0000, v60
    v_lshlrev_b32 v22, 16, v61
    v_and_b32 v23, 0xffff0000, v61
    v_mul_f32 v16, v16, v20
    v_mul_f32 v17, v17, v21
    v_mul_f32 v18, v18, v22
    v_mul_f32 v19, v19, v23
    v_cvt_pk_bf16_f32 v24, v16, v17
    v_cvt_pk_bf16_f32 v25, v18, v19
    v_lshlrev_b32 v16, 16, v24
    v_and_b32 v17, 0xffff0000, v24
    v_lshlrev_b32 v18, 16, v25
    v_and_b32 v19, 0xffff0000, v25
    v_add_f32 v5, v5, v16
    v_add_f32 v5, v5, v17
    v_add_f32 v5, v5, v18
    v_add_f32 v5, v5, v19
    v_lshlrev_b32 v16, 16, v58
    v_and_b32 v17, 0xffff0000, v58
    v_lshlrev_b32 v18, 16, v59
    v_and_b32 v19, 0xffff0000, v59
    v_lshlrev_b32 v20, 16, v62
    v_and_b32 v21, 0xffff0000, v62
    v_lshlrev_b32 v22, 16, v63
    v_and_b32 v23, 0xffff0000, v63
    v_mul_f32 v16, v16, v20
    v_mul_f32 v17, v17, v21
    v_mul_f32 v18, v18, v22
    v_mul_f32 v19, v19, v23
    v_cvt_pk_bf16_f32 v24, v16, v17
    v_cvt_pk_bf16_f32 v25, v18, v19
    v_lshlrev_b32 v16, 16, v24
    v_and_b32 v17, 0xffff0000, v24
    v_lshlrev_b32 v18, 16, v25
    v_and_b32 v19, 0xffff0000, v25
    v_add_f32 v5, v5, v16
    v_add_f32 v5, v5, v17
    v_add_f32 v5, v5, v18
    v_add_f32 v5, v5, v19
    s_waitcnt vmcnt(30)
    v_lshlrev_b32 v16, 16, v64
    v_and_b32 v17, 0xffff0000, v64
    v_lshlrev_b32 v18, 16, v65
    v_and_b32 v19, 0xffff0000, v65
    v_lshlrev_b32 v20, 16, v68
    v_and_b32 v21, 0xffff0000, v68
    v_lshlrev_b32 v22, 16, v69
    v_and_b32 v23, 0xffff0000, v69
    v_mul_f32 v16, v16, v20
    v_mul_f32 v17, v17, v21
    v_mul_f32 v18, v18, v22
    v_mul_f32 v19, v19, v23
    v_cvt_pk_bf16_f32 v24, v16, v17
    v_cvt_pk_bf16_f32 v25, v18, v19
    v_lshlrev_b32 v16, 16, v24
    v_and_b32 v17, 0xffff0000, v24
    v_lshlrev_b32 v18, 16, v25
    v_and_b32 v19, 0xffff0000, v25
    v_add_f32 v5, v5, v16
    v_add_f32 v5, v5, v17
    v_add_f32 v5, v5, v18
    v_add_f32 v5, v5, v19
    v_lshlrev_b32 v16, 16, v66
    v_and_b32 v17, 0xffff0000, v66
    v_lshlrev_b32 v18, 16, v67
    v_and_b32 v19, 0xffff0000, v67
    v_lshlrev_b32 v20, 16, v70
    v_and_b32 v21, 0xffff0000, v70
    v_lshlrev_b32 v22, 16, v71
    v_and_b32 v23, 0xffff0000, v71
    v_mul_f32 v16, v16, v20
    v_mul_f32 v17, v17, v21
    v_mul_f32 v18, v18, v22
    v_mul_f32 v19, v19, v23
    v_cvt_pk_bf16_f32 v24, v16, v17
    v_cvt_pk_bf16_f32 v25, v18, v19
    v_lshlrev_b32 v16, 16, v24
    v_and_b32 v17, 0xffff0000, v24
    v_lshlrev_b32 v18, 16, v25
    v_and_b32 v19, 0xffff0000, v25
    v_add_f32 v5, v5, v16
    v_add_f32 v5, v5, v17
    v_add_f32 v5, v5, v18
    v_add_f32 v5, v5, v19
    s_waitcnt vmcnt(28)
    v_lshlrev_b32 v16, 16, v72
    v_and_b32 v17, 0xffff0000, v72
    v_lshlrev_b32 v18, 16, v73
    v_and_b32 v19, 0xffff0000, v73
    v_lshlrev_b32 v20, 16, v76
    v_and_b32 v21, 0xffff0000, v76
    v_lshlrev_b32 v22, 16, v77
    v_and_b32 v23, 0xffff0000, v77
    v_mul_f32 v16, v16, v20
    v_mul_f32 v17, v17, v21
    v_mul_f32 v18, v18, v22
    v_mul_f32 v19, v19, v23
    v_cvt_pk_bf16_f32 v24, v16, v17
    v_cvt_pk_bf16_f32 v25, v18, v19
    v_lshlrev_b32 v16, 16, v24
    v_and_b32 v17, 0xffff0000, v24
    v_lshlrev_b32 v18, 16, v25
    v_and_b32 v19, 0xffff0000, v25
    v_add_f32 v5, v5, v16
    v_add_f32 v5, v5, v17
    v_add_f32 v5, v5, v18
    v_add_f32 v5, v5, v19
    v_lshlrev_b32 v16, 16, v74
    v_and_b32 v17, 0xffff0000, v74
    v_lshlrev_b32 v18, 16, v75
    v_and_b32 v19, 0xffff0000, v75
    v_lshlrev_b32 v20, 16, v78
    v_and_b32 v21, 0xffff0000, v78
    v_lshlrev_b32 v22, 16, v79
    v_and_b32 v23, 0xffff0000, v79
    v_mul_f32 v16, v16, v20
    v_mul_f32 v17, v17, v21
    v_mul_f32 v18, v18, v22
    v_mul_f32 v19, v19, v23
    v_cvt_pk_bf16_f32 v24, v16, v17
    v_cvt_pk_bf16_f32 v25, v18, v19
    v_lshlrev_b32 v16, 16, v24
    v_and_b32 v17, 0xffff0000, v24
    v_lshlrev_b32 v18, 16, v25
    v_and_b32 v19, 0xffff0000, v25
    v_add_f32 v5, v5, v16
    v_add_f32 v5, v5, v17
    v_add_f32 v5, v5, v18
    v_add_f32 v5, v5, v19
    s_waitcnt vmcnt(26)
    v_lshlrev_b32 v16, 16, v80
    v_and_b32 v17, 0xffff0000, v80
    v_lshlrev_b32 v18, 16, v81
    v_and_b32 v19, 0xffff0000, v81
    v_lshlrev_b32 v20, 16, v84
    v_and_b32 v21, 0xffff0000, v84
    v_lshlrev_b32 v22, 16, v85
    v_and_b32 v23, 0xffff0000, v85
    v_mul_f32 v16, v16, v20
    v_mul_f32 v17, v17, v21
    v_mul_f32 v18, v18, v22
    v_mul_f32 v19, v19, v23
    v_cvt_pk_bf16_f32 v24, v16, v17
    v_cvt_pk_bf16_f32 v25, v18, v19
    v_lshlrev_b32 v16, 16, v24
    v_and_b32 v17, 0xffff0000, v24
    v_lshlrev_b32 v18, 16, v25
    v_and_b32 v19, 0xffff0000, v25
    v_add_f32 v5, v5, v16
    v_add_f32 v5, v5, v17
    v_add_f32 v5, v5, v18
    v_add_f32 v5, v5, v19
    v_lshlrev_b32 v16, 16, v82
    v_and_b32 v17, 0xffff0000, v82
    v_lshlrev_b32 v18, 16, v83
    v_and_b32 v19, 0xffff0000, v83
    v_lshlrev_b32 v20, 16, v86
    v_and_b32 v21, 0xffff0000, v86
    v_lshlrev_b32 v22, 16, v87
    v_and_b32 v23, 0xffff0000, v87
    v_mul_f32 v16, v16, v20
    v_mul_f32 v17, v17, v21
    v_mul_f32 v18, v18, v22
    v_mul_f32 v19, v19, v23
    v_cvt_pk_bf16_f32 v24, v16, v17
    v_cvt_pk_bf16_f32 v25, v18, v19
    v_lshlrev_b32 v16, 16, v24
    v_and_b32 v17, 0xffff0000, v24
    v_lshlrev_b32 v18, 16, v25
    v_and_b32 v19, 0xffff0000, v25
    v_add_f32 v5, v5, v16
    v_add_f32 v5, v5, v17
    v_add_f32 v5, v5, v18
    v_add_f32 v5, v5, v19
    s_waitcnt vmcnt(24)
    v_lshlrev_b32 v16, 16, v88
    v_and_b32 v17, 0xffff0000, v88
    v_lshlrev_b32 v18, 16, v89
    v_and_b32 v19, 0xffff0000, v89
    v_lshlrev_b32 v20, 16, v92
    v_and_b32 v21, 0xffff0000, v92
    v_lshlrev_b32 v22, 16, v93
    v_and_b32 v23, 0xffff0000, v93
    v_mul_f32 v16, v16, v20
    v_mul_f32 v17, v17, v21
    v_mul_f32 v18, v18, v22
    v_mul_f32 v19, v19, v23
    v_cvt_pk_bf16_f32 v24, v16, v17
    v_cvt_pk_bf16_f32 v25, v18, v19
    v_lshlrev_b32 v16, 16, v24
    v_and_b32 v17, 0xffff0000, v24
    v_lshlrev_b32 v18, 16, v25
    v_and_b32 v19, 0xffff0000, v25
    v_add_f32 v5, v5, v16
    v_add_f32 v5, v5, v17
    v_add_f32 v5, v5, v18
    v_add_f32 v5, v5, v19
    v_lshlrev_b32 v16, 16, v90
    v_and_b32 v17, 0xffff0000, v90
    v_lshlrev_b32 v18, 16, v91
    v_and_b32 v19, 0xffff0000, v91
    v_lshlrev_b32 v20, 16, v94
    v_and_b32 v21, 0xffff0000, v94
    v_lshlrev_b32 v22, 16, v95
    v_and_b32 v23, 0xffff0000, v95
    v_mul_f32 v16, v16, v20
    v_mul_f32 v17, v17, v21
    v_mul_f32 v18, v18, v22
    v_mul_f32 v19, v19, v23
    v_cvt_pk_bf16_f32 v24, v16, v17
    v_cvt_pk_bf16_f32 v25, v18, v19
    v_lshlrev_b32 v16, 16, v24
    v_and_b32 v17, 0xffff0000, v24
    v_lshlrev_b32 v18, 16, v25
    v_and_b32 v19, 0xffff0000, v25
    v_add_f32 v5, v5, v16
    v_add_f32 v5, v5, v17
    v_add_f32 v5, v5, v18
    v_add_f32 v5, v5, v19
    s_waitcnt vmcnt(22)
    v_lshlrev_b32 v16, 16, v96
    v_and_b32 v17, 0xffff0000, v96
    v_lshlrev_b32 v18, 16, v97
    v_and_b32 v19, 0xffff0000, v97
    v_lshlrev_b32 v20, 16, v100
    v_and_b32 v21, 0xffff0000, v100
    v_lshlrev_b32 v22, 16, v101
    v_and_b32 v23, 0xffff0000, v101
    v_mul_f32 v16, v16, v20
    v_mul_f32 v17, v17, v21
    v_mul_f32 v18, v18, v22
    v_mul_f32 v19, v19, v23
    v_cvt_pk_bf16_f32 v24, v16, v17
    v_cvt_pk_bf16_f32 v25, v18, v19
    v_lshlrev_b32 v16, 16, v24
    v_and_b32 v17, 0xffff0000, v24
    v_lshlrev_b32 v18, 16, v25
    v_and_b32 v19, 0xffff0000, v25
    v_add_f32 v5, v5, v16
    v_add_f32 v5, v5, v17
    v_add_f32 v5, v5, v18
    v_add_f32 v5, v5, v19
    v_lshlrev_b32 v16, 16, v98
    v_and_b32 v17, 0xffff0000, v98
    v_lshlrev_b32 v18, 16, v99
    v_and_b32 v19, 0xffff0000, v99
    v_lshlrev_b32 v20, 16, v102
    v_and_b32 v21, 0xffff0000, v102
    v_lshlrev_b32 v22, 16, v103
    v_and_b32 v23, 0xffff0000, v103
    v_mul_f32 v16, v16, v20
    v_mul_f32 v17, v17, v21
    v_mul_f32 v18, v18, v22
    v_mul_f32 v19, v19, v23
    v_cvt_pk_bf16_f32 v24, v16, v17
    v_cvt_pk_bf16_f32 v25, v18, v19
    v_lshlrev_b32 v16, 16, v24
    v_and_b32 v17, 0xffff0000, v24
    v_lshlrev_b32 v18, 16, v25
    v_and_b32 v19, 0xffff0000, v25
    v_add_f32 v5, v5, v16
    v_add_f32 v5, v5, v17
    v_add_f32 v5, v5, v18
    v_add_f32 v5, v5, v19
    s_waitcnt vmcnt(20)
    v_lshlrev_b32 v16, 16, v104
    v_and_b32 v17, 0xffff0000, v104
    v_lshlrev_b32 v18, 16, v105
    v_and_b32 v19, 0xffff0000, v105
    v_lshlrev_b32 v20, 16, v108
    v_and_b32 v21, 0xffff0000, v108
    v_lshlrev_b32 v22, 16, v109
    v_and_b32 v23, 0xffff0000, v109
    v_mul_f32 v16, v16, v20
    v_mul_f32 v17, v17, v21
    v_mul_f32 v18, v18, v22
    v_mul_f32 v19, v19, v23
    v_cvt_pk_bf16_f32 v24, v16, v17
    v_cvt_pk_bf16_f32 v25, v18, v19
    v_lshlrev_b32 v16, 16, v24
    v_and_b32 v17, 0xffff0000, v24
    v_lshlrev_b32 v18, 16, v25
    v_and_b32 v19, 0xffff0000, v25
    v_add_f32 v5, v5, v16
    v_add_f32 v5, v5, v17
    v_add_f32 v5, v5, v18
    v_add_f32 v5, v5, v19
    v_lshlrev_b32 v16, 16, v106
    v_and_b32 v17, 0xffff0000, v106
    v_lshlrev_b32 v18, 16, v107
    v_and_b32 v19, 0xffff0000, v107
    v_lshlrev_b32 v20, 16, v110
    v_and_b32 v21, 0xffff0000, v110
    v_lshlrev_b32 v22, 16, v111
    v_and_b32 v23, 0xffff0000, v111
    v_mul_f32 v16, v16, v20
    v_mul_f32 v17, v17, v21
    v_mul_f32 v18, v18, v22
    v_mul_f32 v19, v19, v23
    v_cvt_pk_bf16_f32 v24, v16, v17
    v_cvt_pk_bf16_f32 v25, v18, v19
    v_lshlrev_b32 v16, 16, v24
    v_and_b32 v17, 0xffff0000, v24
    v_lshlrev_b32 v18, 16, v25
    v_and_b32 v19, 0xffff0000, v25
    v_add_f32 v5, v5, v16
    v_add_f32 v5, v5, v17
    v_add_f32 v5, v5, v18
    v_add_f32 v5, v5, v19
    s_waitcnt vmcnt(18)
    v_lshlrev_b32 v16, 16, v112
    v_and_b32 v17, 0xffff0000, v112
    v_lshlrev_b32 v18, 16, v113
    v_and_b32 v19, 0xffff0000, v113
    v_lshlrev_b32 v20, 16, v116
    v_and_b32 v21, 0xffff0000, v116
    v_lshlrev_b32 v22, 16, v117
    v_and_b32 v23, 0xffff0000, v117
    v_mul_f32 v16, v16, v20
    v_mul_f32 v17, v17, v21
    v_mul_f32 v18, v18, v22
    v_mul_f32 v19, v19, v23
    v_cvt_pk_bf16_f32 v24, v16, v17
    v_cvt_pk_bf16_f32 v25, v18, v19
    v_lshlrev_b32 v16, 16, v24
    v_and_b32 v17, 0xffff0000, v24
    v_lshlrev_b32 v18, 16, v25
    v_and_b32 v19, 0xffff0000, v25
    v_add_f32 v5, v5, v16
    v_add_f32 v5, v5, v17
    v_add_f32 v5, v5, v18
    v_add_f32 v5, v5, v19
    v_lshlrev_b32 v16, 16, v114
    v_and_b32 v17, 0xffff0000, v114
    v_lshlrev_b32 v18, 16, v115
    v_and_b32 v19, 0xffff0000, v115
    v_lshlrev_b32 v20, 16, v118
    v_and_b32 v21, 0xffff0000, v118
    v_lshlrev_b32 v22, 16, v119
    v_and_b32 v23, 0xffff0000, v119
    v_mul_f32 v16, v16, v20
    v_mul_f32 v17, v17, v21
    v_mul_f32 v18, v18, v22
    v_mul_f32 v19, v19, v23
    v_cvt_pk_bf16_f32 v24, v16, v17
    v_cvt_pk_bf16_f32 v25, v18, v19
    v_lshlrev_b32 v16, 16, v24
    v_and_b32 v17, 0xffff0000, v24
    v_lshlrev_b32 v18, 16, v25
    v_and_b32 v19, 0xffff0000, v25
    v_add_f32 v5, v5, v16
    v_add_f32 v5, v5, v17
    v_add_f32 v5, v5, v18
    v_add_f32 v5, v5, v19
    s_waitcnt vmcnt(16)
    v_lshlrev_b32 v16, 16, v120
    v_and_b32 v17, 0xffff0000, v120
    v_lshlrev_b32 v18, 16, v121
    v_and_b32 v19, 0xffff0000, v121
    v_lshlrev_b32 v20, 16, v124
    v_and_b32 v21, 0xffff0000, v124
    v_lshlrev_b32 v22, 16, v125
    v_and_b32 v23, 0xffff0000, v125
    v_mul_f32 v16, v16, v20
    v_mul_f32 v17, v17, v21
    v_mul_f32 v18, v18, v22
    v_mul_f32 v19, v19, v23
    v_cvt_pk_bf16_f32 v24, v16, v17
    v_cvt_pk_bf16_f32 v25, v18, v19
    v_lshlrev_b32 v16, 16, v24
    v_and_b32 v17, 0xffff0000, v24
    v_lshlrev_b32 v18, 16, v25
    v_and_b32 v19, 0xffff0000, v25
    v_add_f32 v5, v5, v16
    v_add_f32 v5, v5, v17
    v_add_f32 v5, v5, v18
    v_add_f32 v5, v5, v19
    v_lshlrev_b32 v16, 16, v122
    v_and_b32 v17, 0xffff0000, v122
    v_lshlrev_b32 v18, 16, v123
    v_and_b32 v19, 0xffff0000, v123
    v_lshlrev_b32 v20, 16, v126
    v_and_b32 v21, 0xffff0000, v126
    v_lshlrev_b32 v22, 16, v127
    v_and_b32 v23, 0xffff0000, v127
    v_mul_f32 v16, v16, v20
    v_mul_f32 v17, v17, v21
    v_mul_f32 v18, v18, v22
    v_mul_f32 v19, v19, v23
    v_cvt_pk_bf16_f32 v24, v16, v17
    v_cvt_pk_bf16_f32 v25, v18, v19
    v_lshlrev_b32 v16, 16, v24
    v_and_b32 v17, 0xffff0000, v24
    v_lshlrev_b32 v18, 16, v25
    v_and_b32 v19, 0xffff0000, v25
    v_add_f32 v5, v5, v16
    v_add_f32 v5, v5, v17
    v_add_f32 v5, v5, v18
    v_add_f32 v5, v5, v19
    s_waitcnt vmcnt(14)
    v_lshlrev_b32 v16, 16, v128
    v_and_b32 v17, 0xffff0000, v128
    v_lshlrev_b32 v18, 16, v129
    v_and_b32 v19, 0xffff0000, v129
    v_lshlrev_b32 v20, 16, v132
    v_and_b32 v21, 0xffff0000, v132
    v_lshlrev_b32 v22, 16, v133
    v_and_b32 v23, 0xffff0000, v133
    v_mul_f32 v16, v16, v20
    v_mul_f32 v17, v17, v21
    v_mul_f32 v18, v18, v22
    v_mul_f32 v19, v19, v23
    v_cvt_pk_bf16_f32 v24, v16, v17
    v_cvt_pk_bf16_f32 v25, v18, v19
    v_lshlrev_b32 v16, 16, v24
    v_and_b32 v17, 0xffff0000, v24
    v_lshlrev_b32 v18, 16, v25
    v_and_b32 v19, 0xffff0000, v25
    v_add_f32 v5, v5, v16
    v_add_f32 v5, v5, v17
    v_add_f32 v5, v5, v18
    v_add_f32 v5, v5, v19
    v_lshlrev_b32 v16, 16, v130
    v_and_b32 v17, 0xffff0000, v130
    v_lshlrev_b32 v18, 16, v131
    v_and_b32 v19, 0xffff0000, v131
    v_lshlrev_b32 v20, 16, v134
    v_and_b32 v21, 0xffff0000, v134
    v_lshlrev_b32 v22, 16, v135
    v_and_b32 v23, 0xffff0000, v135
    v_mul_f32 v16, v16, v20
    v_mul_f32 v17, v17, v21
    v_mul_f32 v18, v18, v22
    v_mul_f32 v19, v19, v23
    v_cvt_pk_bf16_f32 v24, v16, v17
    v_cvt_pk_bf16_f32 v25, v18, v19
    v_lshlrev_b32 v16, 16, v24
    v_and_b32 v17, 0xffff0000, v24
    v_lshlrev_b32 v18, 16, v25
    v_and_b32 v19, 0xffff0000, v25
    v_add_f32 v5, v5, v16
    v_add_f32 v5, v5, v17
    v_add_f32 v5, v5, v18
    v_add_f32 v5, v5, v19
    s_waitcnt vmcnt(12)
    v_lshlrev_b32 v16, 16, v136
    v_and_b32 v17, 0xffff0000, v136
    v_lshlrev_b32 v18, 16, v137
    v_and_b32 v19, 0xffff0000, v137
    v_lshlrev_b32 v20, 16, v140
    v_and_b32 v21, 0xffff0000, v140
    v_lshlrev_b32 v22, 16, v141
    v_and_b32 v23, 0xffff0000, v141
    v_mul_f32 v16, v16, v20
    v_mul_f32 v17, v17, v21
    v_mul_f32 v18, v18, v22
    v_mul_f32 v19, v19, v23
    v_cvt_pk_bf16_f32 v24, v16, v17
    v_cvt_pk_bf16_f32 v25, v18, v19
    v_lshlrev_b32 v16, 16, v24
    v_and_b32 v17, 0xffff0000, v24
    v_lshlrev_b32 v18, 16, v25
    v_and_b32 v19, 0xffff0000, v25
    v_add_f32 v5, v5, v16
    v_add_f32 v5, v5, v17
    v_add_f32 v5, v5, v18
    v_add_f32 v5, v5, v19
    v_lshlrev_b32 v16, 16, v138
    v_and_b32 v17, 0xffff0000, v138
    v_lshlrev_b32 v18, 16, v139
    v_and_b32 v19, 0xffff0000, v139
    v_lshlrev_b32 v20, 16, v142
    v_and_b32 v21, 0xffff0000, v142
    v_lshlrev_b32 v22, 16, v143
    v_and_b32 v23, 0xffff0000, v143
    v_mul_f32 v16, v16, v20
    v_mul_f32 v17, v17, v21
    v_mul_f32 v18, v18, v22
    v_mul_f32 v19, v19, v23
    v_cvt_pk_bf16_f32 v24, v16, v17
    v_cvt_pk_bf16_f32 v25, v18, v19
    v_lshlrev_b32 v16, 16, v24
    v_and_b32 v17, 0xffff0000, v24
    v_lshlrev_b32 v18, 16, v25
    v_and_b32 v19, 0xffff0000, v25
    v_add_f32 v5, v5, v16
    v_add_f32 v5, v5, v17
    v_add_f32 v5, v5, v18
    v_add_f32 v5, v5, v19
    s_waitcnt vmcnt(10)
    v_lshlrev_b32 v16, 16, v144
    v_and_b32 v17, 0xffff0000, v144
    v_lshlrev_b32 v18, 16, v145
    v_and_b32 v19, 0xffff0000, v145
    v_lshlrev_b32 v20, 16, v148
    v_and_b32 v21, 0xffff0000, v148
    v_lshlrev_b32 v22, 16, v149
    v_and_b32 v23, 0xffff0000, v149
    v_mul_f32 v16, v16, v20
    v_mul_f32 v17, v17, v21
    v_mul_f32 v18, v18, v22
    v_mul_f32 v19, v19, v23
    v_cvt_pk_bf16_f32 v24, v16, v17
    v_cvt_pk_bf16_f32 v25, v18, v19
    v_lshlrev_b32 v16, 16, v24
    v_and_b32 v17, 0xffff0000, v24
    v_lshlrev_b32 v18, 16, v25
    v_and_b32 v19, 0xffff0000, v25
    v_add_f32 v5, v5, v16
    v_add_f32 v5, v5, v17
    v_add_f32 v5, v5, v18
    v_add_f32 v5, v5, v19
    v_lshlrev_b32 v16, 16, v146
    v_and_b32 v17, 0xffff0000, v146
    v_lshlrev_b32 v18, 16, v147
    v_and_b32 v19, 0xffff0000, v147
    v_lshlrev_b32 v20, 16, v150
    v_and_b32 v21, 0xffff0000, v150
    v_lshlrev_b32 v22, 16, v151
    v_and_b32 v23, 0xffff0000, v151
    v_mul_f32 v16, v16, v20
    v_mul_f32 v17, v17, v21
    v_mul_f32 v18, v18, v22
    v_mul_f32 v19, v19, v23
    v_cvt_pk_bf16_f32 v24, v16, v17
    v_cvt_pk_bf16_f32 v25, v18, v19
    v_lshlrev_b32 v16, 16, v24
    v_and_b32 v17, 0xffff0000, v24
    v_lshlrev_b32 v18, 16, v25
    v_and_b32 v19, 0xffff0000, v25
    v_add_f32 v5, v5, v16
    v_add_f32 v5, v5, v17
    v_add_f32 v5, v5, v18
    v_add_f32 v5, v5, v19
    s_waitcnt vmcnt(8)
    v_lshlrev_b32 v16, 16, v152
    v_and_b32 v17, 0xffff0000, v152
    v_lshlrev_b32 v18, 16, v153
    v_and_b32 v19, 0xffff0000, v153
    v_lshlrev_b32 v20, 16, v156
    v_and_b32 v21, 0xffff0000, v156
    v_lshlrev_b32 v22, 16, v157
    v_and_b32 v23, 0xffff0000, v157
    v_mul_f32 v16, v16, v20
    v_mul_f32 v17, v17, v21
    v_mul_f32 v18, v18, v22
    v_mul_f32 v19, v19, v23
    v_cvt_pk_bf16_f32 v24, v16, v17
    v_cvt_pk_bf16_f32 v25, v18, v19
    v_lshlrev_b32 v16, 16, v24
    v_and_b32 v17, 0xffff0000, v24
    v_lshlrev_b32 v18, 16, v25
    v_and_b32 v19, 0xffff0000, v25
    v_add_f32 v5, v5, v16
    v_add_f32 v5, v5, v17
    v_add_f32 v5, v5, v18
    v_add_f32 v5, v5, v19
    v_lshlrev_b32 v16, 16, v154
    v_and_b32 v17, 0xffff0000, v154
    v_lshlrev_b32 v18, 16, v155
    v_and_b32 v19, 0xffff0000, v155
    v_lshlrev_b32 v20, 16, v158
    v_and_b32 v21, 0xffff0000, v158
    v_lshlrev_b32 v22, 16, v159
    v_and_b32 v23, 0xffff0000, v159
    v_mul_f32 v16, v16, v20
    v_mul_f32 v17, v17, v21
    v_mul_f32 v18, v18, v22
    v_mul_f32 v19, v19, v23
    v_cvt_pk_bf16_f32 v24, v16, v17
    v_cvt_pk_bf16_f32 v25, v18, v19
    v_lshlrev_b32 v16, 16, v24
    v_and_b32 v17, 0xffff0000, v24
    v_lshlrev_b32 v18, 16, v25
    v_and_b32 v19, 0xffff0000, v25
    v_add_f32 v5, v5, v16
    v_add_f32 v5, v5, v17
    v_add_f32 v5, v5, v18
    v_add_f32 v5, v5, v19
    s_waitcnt vmcnt(6)
    v_lshlrev_b32 v16, 16, v160
    v_and_b32 v17, 0xffff0000, v160
    v_lshlrev_b32 v18, 16, v161
    v_and_b32 v19, 0xffff0000, v161
    v_lshlrev_b32 v20, 16, v164
    v_and_b32 v21, 0xffff0000, v164
    v_lshlrev_b32 v22, 16, v165
    v_and_b32 v23, 0xffff0000, v165
    v_mul_f32 v16, v16, v20
    v_mul_f32 v17, v17, v21
    v_mul_f32 v18, v18, v22
    v_mul_f32 v19, v19, v23
    v_cvt_pk_bf16_f32 v24, v16, v17
    v_cvt_pk_bf16_f32 v25, v18, v19
    v_lshlrev_b32 v16, 16, v24
    v_and_b32 v17, 0xffff0000, v24
    v_lshlrev_b32 v18, 16, v25
    v_and_b32 v19, 0xffff0000, v25
    v_add_f32 v5, v5, v16
    v_add_f32 v5, v5, v17
    v_add_f32 v5, v5, v18
    v_add_f32 v5, v5, v19
    v_lshlrev_b32 v16, 16, v162
    v_and_b32 v17, 0xffff0000, v162
    v_lshlrev_b32 v18, 16, v163
    v_and_b32 v19, 0xffff0000, v163
    v_lshlrev_b32 v20, 16, v166
    v_and_b32 v21, 0xffff0000, v166
    v_lshlrev_b32 v22, 16, v167
    v_and_b32 v23, 0xffff0000, v167
    v_mul_f32 v16, v16, v20
    v_mul_f32 v17, v17, v21
    v_mul_f32 v18, v18, v22
    v_mul_f32 v19, v19, v23
    v_cvt_pk_bf16_f32 v24, v16, v17
    v_cvt_pk_bf16_f32 v25, v18, v19
    v_lshlrev_b32 v16, 16, v24
    v_and_b32 v17, 0xffff0000, v24
    v_lshlrev_b32 v18, 16, v25
    v_and_b32 v19, 0xffff0000, v25
    v_add_f32 v5, v5, v16
    v_add_f32 v5, v5, v17
    v_add_f32 v5, v5, v18
    v_add_f32 v5, v5, v19
    s_waitcnt vmcnt(4)
    v_lshlrev_b32 v16, 16, v168
    v_and_b32 v17, 0xffff0000, v168
    v_lshlrev_b32 v18, 16, v169
    v_and_b32 v19, 0xffff0000, v169
    v_lshlrev_b32 v20, 16, v172
    v_and_b32 v21, 0xffff0000, v172
    v_lshlrev_b32 v22, 16, v173
    v_and_b32 v23, 0xffff0000, v173
    v_mul_f32 v16, v16, v20
    v_mul_f32 v17, v17, v21
    v_mul_f32 v18, v18, v22
    v_mul_f32 v19, v19, v23
    v_cvt_pk_bf16_f32 v24, v16, v17
    v_cvt_pk_bf16_f32 v25, v18, v19
    v_lshlrev_b32 v16, 16, v24
    v_and_b32 v17, 0xffff0000, v24
    v_lshlrev_b32 v18, 16, v25
    v_and_b32 v19, 0xffff0000, v25
    v_add_f32 v5, v5, v16
    v_add_f32 v5, v5, v17
    v_add_f32 v5, v5, v18
    v_add_f32 v5, v5, v19
    v_lshlrev_b32 v16, 16, v170
    v_and_b32 v17, 0xffff0000, v170
    v_lshlrev_b32 v18, 16, v171
    v_and_b32 v19, 0xffff0000, v171
    v_lshlrev_b32 v20, 16, v174
    v_and_b32 v21, 0xffff0000, v174
    v_lshlrev_b32 v22, 16, v175
    v_and_b32 v23, 0xffff0000, v175
    v_mul_f32 v16, v16, v20
    v_mul_f32 v17, v17, v21
    v_mul_f32 v18, v18, v22
    v_mul_f32 v19, v19, v23
    v_cvt_pk_bf16_f32 v24, v16, v17
    v_cvt_pk_bf16_f32 v25, v18, v19
    v_lshlrev_b32 v16, 16, v24
    v_and_b32 v17, 0xffff0000, v24
    v_lshlrev_b32 v18, 16, v25
    v_and_b32 v19, 0xffff0000, v25
    v_add_f32 v5, v5, v16
    v_add_f32 v5, v5, v17
    v_add_f32 v5, v5, v18
    v_add_f32 v5, v5, v19
    s_waitcnt vmcnt(2)
    v_lshlrev_b32 v16, 16, v176
    v_and_b32 v17, 0xffff0000, v176
    v_lshlrev_b32 v18, 16, v177
    v_and_b32 v19, 0xffff0000, v177
    v_lshlrev_b32 v20, 16, v180
    v_and_b32 v21, 0xffff0000, v180
    v_lshlrev_b32 v22, 16, v181
    v_and_b32 v23, 0xffff0000, v181
    v_mul_f32 v16, v16, v20
    v_mul_f32 v17, v17, v21
    v_mul_f32 v18, v18, v22
    v_mul_f32 v19, v19, v23
    v_cvt_pk_bf16_f32 v24, v16, v17
    v_cvt_pk_bf16_f32 v25, v18, v19
    v_lshlrev_b32 v16, 16, v24
    v_and_b32 v17, 0xffff0000, v24
    v_lshlrev_b32 v18, 16, v25
    v_and_b32 v19, 0xffff0000, v25
    v_add_f32 v5, v5, v16
    v_add_f32 v5, v5, v17
    v_add_f32 v5, v5, v18
    v_add_f32 v5, v5, v19
    v_lshlrev_b32 v16, 16, v178
    v_and_b32 v17, 0xffff0000, v178
    v_lshlrev_b32 v18, 16, v179
    v_and_b32 v19, 0xffff0000, v179
    v_lshlrev_b32 v20, 16, v182
    v_and_b32 v21, 0xffff0000, v182
    v_lshlrev_b32 v22, 16, v183
    v_and_b32 v23, 0xffff0000, v183
    v_mul_f32 v16, v16, v20
    v_mul_f32 v17, v17, v21
    v_mul_f32 v18, v18, v22
    v_mul_f32 v19, v19, v23
    v_cvt_pk_bf16_f32 v24, v16, v17
    v_cvt_pk_bf16_f32 v25, v18, v19
    v_lshlrev_b32 v16, 16, v24
    v_and_b32 v17, 0xffff0000, v24
    v_lshlrev_b32 v18, 16, v25
    v_and_b32 v19, 0xffff0000, v25
    v_add_f32 v5, v5, v16
    v_add_f32 v5, v5, v17
    v_add_f32 v5, v5, v18
    v_add_f32 v5, v5, v19
    s_waitcnt vmcnt(0)
    v_lshlrev_b32 v16, 16, v184
    v_and_b32 v17, 0xffff0000, v184
    v_lshlrev_b32 v18, 16, v185
    v_and_b32 v19, 0xffff0000, v185
    v_lshlrev_b32 v20, 16, v188
    v_and_b32 v21, 0xffff0000, v188
    v_lshlrev_b32 v22, 16, v189
    v_and_b32 v23, 0xffff0000, v189
    v_mul_f32 v16, v16, v20
    v_mul_f32 v17, v17, v21
    v_mul_f32 v18, v18, v22
    v_mul_f32 v19, v19, v23
    v_cvt_pk_bf16_f32 v24, v16, v17
    v_cvt_pk_bf16_f32 v25, v18, v19
    v_lshlrev_b32 v16, 16, v24
    v_and_b32 v17, 0xffff0000, v24
    v_lshlrev_b32 v18, 16, v25
    v_and_b32 v19, 0xffff0000, v25
    v_add_f32 v5, v5, v16
    v_add_f32 v5, v5, v17
    v_add_f32 v5, v5, v18
    v_add_f32 v5, v5, v19
    v_lshlrev_b32 v16, 16, v186
    v_and_b32 v17, 0xffff0000, v186
    v_lshlrev_b32 v18, 16, v187
    v_and_b32 v19, 0xffff0000, v187
    v_lshlrev_b32 v20, 16, v190
    v_and_b32 v21, 0xffff0000, v190
    v_lshlrev_b32 v22, 16, v191
    v_and_b32 v23, 0xffff0000, v191
    v_mul_f32 v16, v16, v20
    v_mul_f32 v17, v17, v21
    v_mul_f32 v18, v18, v22
    v_mul_f32 v19, v19, v23
    v_cvt_pk_bf16_f32 v24, v16, v17
    v_cvt_pk_bf16_f32 v25, v18, v19
    v_lshlrev_b32 v16, 16, v24
    v_and_b32 v17, 0xffff0000, v24
    v_lshlrev_b32 v18, 16, v25
    v_and_b32 v19, 0xffff0000, v25
    v_add_f32 v5, v5, v16
    v_add_f32 v5, v5, v17
    v_add_f32 v5, v5, v18
    v_add_f32 v5, v5, v19
    s_nop 1
    v_add_f32_dpp v6, v5, v5 quad_perm:[1,0,3,2] row_mask:0xf bank_mask:0xf
    s_nop 1
    v_add_f32_dpp v5, v6, v6 quad_perm:[2,3,0,1] row_mask:0xf bank_mask:0xf
    v_cvt_pk_bf16_f32 v5, v5, v5
    v_lshlrev_b32 v5, 16, v5
    v_mul_f32 v5, 0xbfb8aa3b, v5
    v_exp_f32 v5, v5
    s_nop 0
    v_add_f32 v5, 1.0, v5
    v_rcp_f32 v5, v5
    s_nop 0
    v_cvt_pk_bf16_f32 v5, v5, v5
    v_lshlrev_b32 v5, 16, v5
    v_lshlrev_b32 v1, 2, v1
    v_add_u32 v1, 20185088, v1
    buffer_store_dword v5, v1, s[20:23], 0 offen
k1_end:
    s_endpgm
.globl k2_kernel
.p2align 8
.type k2_kernel,@function
k2_kernel:
    s_load_dwordx16 s[44:59], s[0:1], 0
    s_load_dwordx4 s[60:63], s[0:1], 64
    s_load_dwordx2 s[64:65], s[0:1], 80
    s_waitcnt lgkmcnt(0)
    s_cmp_ge_u32 s2, 1184
    s_cbranch_scc1 k2_end
    s_mov_b32 s20, s64
    s_and_b32 s21, s65, 0xffff
    s_mov_b32 s22, 268435456
    s_mov_b32 s23, 0x20000
    s_cmp_ge_u32 s2, 160
    s_cbranch_scc1 k2_att
    s_mov_b32 s8, s64
    s_and_b32 s9, s65, 0xffff
    s_mov_b32 s10, 268435456
    s_mov_b32 s11, 0x20000
    s_mov_b32 s12, s56
    s_and_b32 s13, s57, 0xffff
    s_mov_b32 s14, 2211840
    s_mov_b32 s15, 0x20000
    s_mov_b32 s16, s56
    s_and_b32 s17, s57, 0xffff
    s_mov_b32 s18, 2211840
    s_mov_b32 s19, 0x20000
    s_and_b32 s41, s2, 31
    s_lshr_b32 s42, s2, 5
    s_mul_i32 s31, s41, 221184
    s_add_u32 s31, s31, 7864320
    s_mov_b32 s30, 1280
    s_lshl_b32 s32, s42, 8
    s_add_u32 s33, s32, 128
    v_lshrrev_b32 v1, 6, v0
    v_and_b32 v2, 63, v0
    s_nop 0
    v_readfirstlane_b32 s36, v1
    v_lshrrev_b32 v3, 3, v2
    v_and_b32 v4, 7, v2
    s_mul_i32 s37, s36, 16
    v_xor_b32 v5, v4, v3
    v_lshlrev_b32 v5, 4, v5
    v_add_u32 v6, s37, v3
    s_mov_b32 s27, 3456
    v_mul_lo_u32 v6, v6, s27
    v_add_u32 v10, v6, v5
    s_lshl_b32 s27, s36, 4
    v_add_u32 v6, s27, v3
    v_and_b32 v7, 2, v3
    v_xor_b32 v7, v7, v4
    v_mul_lo_u32 v8, v6, s30
    v_lshl_add_u32 v11, v7, 4, v8
    v_add_u32 v6, 8, v6
    v_xor_b32 v7, 4, v7
    v_mul_lo_u32 v8, v6, s30
    v_lshl_add_u32 v12, v7, 4, v8
    s_mul_i32 s38, s36, 2048
    s_lshl_b32 s39, s36, 11
    s_add_u32 s39, s39, 8192
    s_lshl_b32 s40, s30, 6
    s_lshr_b32 s34, s36, 1
    s_and_b32 s35, s36, 1
    v_and_b32 v3, 15, v2
    v_lshrrev_b32 v4, 4, v2
    s_mul_i32 s27, s34, 4096
    v_and_b32 v5, 7, v3
    v_xor_b32 v5, v5, v4
    v_lshlrev_b32 v5, 4, v5
    v_lshl_add_u32 v5, v3, 7, v5
    v_add_u32 v13, s27, v5
    v_xor_b32 v14, 64, v13
    v_lshrrev_b32 v5, 2, v3
    v_and_b32 v6, 3, v3
    v_and_b32 v7, 2, v5
    v_and_b32 v8, 1, v4
    v_lshl_add_u32 v7, v8, 2, v7
    v_lshl_add_u32 v8, v4, 3, v5
    v_lshlrev_b32 v8, 7, v8
    v_and_b32 v9, 1, v6
    v_lshl_add_u32 v8, v9, 3, v8
    v_add_u32 v8, 8192, v8
    v_lshrrev_b32 v9, 1, v6
    s_lshl_b32 s27, s35, 2
    v_add_u32 v15, 0, v9
    v_add_u32 v15, s27, v15
    v_xor_b32 v15, v15, v7
    v_lshl_add_u32 v15, v15, 4, v8
    v_add_u32 v16, 2, v9
    v_add_u32 v16, s27, v16
    v_xor_b32 v16, v16, v7
    v_lshl_add_u32 v16, v16, 4, v8
    v_mov_b32 v64, 0
    v_mov_b32 v65, 0
    v_mov_b32 v66, 0
    v_mov_b32 v67, 0
    v_mov_b32 v68, 0
    v_mov_b32 v69, 0
    v_mov_b32 v70, 0
    v_mov_b32 v71, 0
    v_mov_b32 v72, 0
    v_mov_b32 v73, 0
    v_mov_b32 v74, 0
    v_mov_b32 v75, 0
    v_mov_b32 v76, 0
    v_mov_b32 v77, 0
    v_mov_b32 v78, 0
    v_mov_b32 v79, 0
    v_mov_b32 v80, 0
    v_mov_b32 v81, 0
    v_mov_b32 v82, 0
    v_mov_b32 v83, 0
    v_mov_b32 v84, 0
    v_mov_b32 v85, 0
    v_mov_b32 v86, 0
    v_mov_b32 v87, 0
    v_mov_b32 v88, 0
    v_mov_b32 v89, 0
    v_mov_b32 v90, 0
    v_mov_b32 v91, 0
    v_mov_b32 v92, 0
    v_mov_b32 v93, 0
    v_mov_b32 v94, 0
    v_mov_b32 v95, 0
    s_mov_b32 s24, s31
    s_mov_b32 s25, 0
    s_mov_b32 s26, 27
    s_add_u32 m0, s38, 0
    s_add_u32 s27, s24, 0
    buffer_load_dwordx4 v10, s[8:11], s27 offen lds
    s_add_u32 m0, s38, 1024
    s_add_u32 s27, s24, 27648
    buffer_load_dwordx4 v10, s[8:11], s27 offen lds
    s_add_u32 m0, s39, 0
    s_add_u32 s27, s25, s32
    buffer_load_dwordx4 v11, s[12:15], s27 offen lds
    s_add_u32 m0, s39, 1024
    s_add_u32 s27, s25, s32
    buffer_load_dwordx4 v12, s[12:15], s27 offen lds
    s_add_u32 m0, s39, 8192
    s_add_u32 s27, s25, s33
    buffer_load_dwordx4 v11, s[16:19], s27 offen lds
    s_add_u32 m0, s39, 9216
    s_add_u32 s27, s25, s33
    buffer_load_dwordx4 v12, s[16:19], s27 offen lds
    s_add_u32 s24, s24, 128
    s_add_u32 s25, s25, s40
    s_add_u32 m0, s38, 24576
    s_add_u32 s27, s24, 0
    buffer_load_dwordx4 v10, s[8:11], s27 offen lds
    s_add_u32 m0, s38, 25600
    s_add_u32 s27, s24, 27648
    buffer_load_dwordx4 v10, s[8:11], s27 offen lds
    s_add_u32 m0, s39, 24576
    s_add_u32 s27, s25, s32
    buffer_load_dwordx4 v11, s[12:15], s27 offen lds
    s_add_u32 m0, s39, 25600
    s_add_u32 s27, s25, s32
    buffer_load_dwordx4 v12, s[12:15], s27 offen lds
    s_add_u32 m0, s39, 32768
    s_add_u32 s27, s25, s33
    buffer_load_dwordx4 v11, s[16:19], s27 offen lds
    s_add_u32 m0, s39, 33792
    s_add_u32 s27, s25, s33
    buffer_load_dwordx4 v12, s[16:19], s27 offen lds
    s_add_u32 s24, s24, 128
    s_add_u32 s25, s25, s40
k2_loop:
    s_waitcnt vmcnt(6)
    s_barrier
    s_add_u32 m0, s38, 49152
    s_add_u32 s27, s24, 0
    buffer_load_dwordx4 v10, s[8:11], s27 offen lds
    s_add_u32 m0, s38, 50176
    s_add_u32 s27, s24, 27648
    buffer_load_dwordx4 v10, s[8:11], s27 offen lds
    s_add_u32 m0, s39, 49152
    s_add_u32 s27, s25, s32
    buffer_load_dwordx4 v11, s[12:15], s27 offen lds
    s_add_u32 m0, s39, 50176
    s_add_u32 s27, s25, s32
    buffer_load_dwordx4 v12, s[12:15], s27 offen lds
    s_add_u32 m0, s39, 57344
    s_add_u32 s27, s25, s33
    buffer_load_dwordx4 v11, s[16:19], s27 offen lds
    s_add_u32 m0, s39, 58368
    s_add_u32 s27, s25, s33
    buffer_load_dwordx4 v12, s[16:19], s27 offen lds
    s_add_u32 s24, s24, 128
    s_add_u32 s25, s25, s40
    ds_read_b128 v[128:131], v13 offset:0
    ds_read_b128 v[132:135], v13 offset:2048
    ds_read_b64_tr_b16 v[144:145], v15 offset:0
    ds_read_b64_tr_b16 v[146:147], v15 offset:512
    ds_read_b64_tr_b16 v[148:149], v16 offset:0
    ds_read_b64_tr_b16 v[150:151], v16 offset:512
    ds_read_b64_tr_b16 v[152:153], v15 offset:8192
    ds_read_b64_tr_b16 v[154:155], v15 offset:8704
    ds_read_b64_tr_b16 v[156:157], v16 offset:8192
    ds_read_b64_tr_b16 v[158:159], v16 offset:8704
    ds_read_b128 v[160:163], v14 offset:0
    ds_read_b128 v[164:167], v14 offset:2048
    ds_read_b64_tr_b16 v[176:177], v15 offset:4096
    ds_read_b64_tr_b16 v[178:179], v15 offset:4608
    ds_read_b64_tr_b16 v[180:181], v16 offset:4096
    ds_read_b64_tr_b16 v[182:183], v16 offset:4608
    ds_read_b64_tr_b16 v[184:185], v15 offset:12288
    ds_read_b64_tr_b16 v[186:187], v15 offset:12800
    ds_read_b64_tr_b16 v[188:189], v16 offset:12288
    ds_read_b64_tr_b16 v[190:191], v16 offset:12800
    s_waitcnt lgkmcnt(10)
    v_mfma_f32_16x16x32_bf16 v[64:67], v[144:147], v[128:131], v[64:67]
    v_mfma_f32_16x16x32_bf16 v[68:71], v[144:147], v[132:135], v[68:71]
    v_mfma_f32_16x16x32_bf16 v[72:75], v[148:151], v[128:131], v[72:75]
    v_mfma_f32_16x16x32_bf16 v[76:79], v[148:151], v[132:135], v[76:79]
    v_mfma_f32_16x16x32_bf16 v[80:83], v[152:155], v[128:131], v[80:83]
    v_mfma_f32_16x16x32_bf16 v[84:87], v[152:155], v[132:135], v[84:87]
    v_mfma_f32_16x16x32_bf16 v[88:91], v[156:159], v[128:131], v[88:91]
    v_mfma_f32_16x16x32_bf16 v[92:95], v[156:159], v[132:135], v[92:95]
    s_waitcnt lgkmcnt(0)
    v_mfma_f32_16x16x32_bf16 v[64:67], v[176:179], v[160:163], v[64:67]
    v_mfma_f32_16x16x32_bf16 v[68:71], v[176:179], v[164:167], v[68:71]
    v_mfma_f32_16x16x32_bf16 v[72:75], v[180:183], v[160:163], v[72:75]
    v_mfma_f32_16x16x32_bf16 v[76:79], v[180:183], v[164:167], v[76:79]
    v_mfma_f32_16x16x32_bf16 v[80:83], v[184:187], v[160:163], v[80:83]
    v_mfma_f32_16x16x32_bf16 v[84:87], v[184:187], v[164:167], v[84:87]
    v_mfma_f32_16x16x32_bf16 v[88:91], v[188:191], v[160:163], v[88:91]
    v_mfma_f32_16x16x32_bf16 v[92:95], v[188:191], v[164:167], v[92:95]
    s_sub_u32 s26, s26, 1
    s_cmp_eq_u32 s26, 0
    s_cbranch_scc1 k2_done
    s_waitcnt vmcnt(6)
    s_barrier
    s_add_u32 m0, s38, 0
    s_add_u32 s27, s24, 0
    buffer_load_dwordx4 v10, s[8:11], s27 offen lds
    s_add_u32 m0, s38, 1024
    s_add_u32 s27, s24, 27648
    buffer_load_dwordx4 v10, s[8:11], s27 offen lds
    s_add_u32 m0, s39, 0
    s_add_u32 s27, s25, s32
    buffer_load_dwordx4 v11, s[12:15], s27 offen lds
    s_add_u32 m0, s39, 1024
    s_add_u32 s27, s25, s32
    buffer_load_dwordx4 v12, s[12:15], s27 offen lds
    s_add_u32 m0, s39, 8192
    s_add_u32 s27, s25, s33
    buffer_load_dwordx4 v11, s[16:19], s27 offen lds
    s_add_u32 m0, s39, 9216
    s_add_u32 s27, s25, s33
    buffer_load_dwordx4 v12, s[16:19], s27 offen lds
    s_add_u32 s24, s24, 128
    s_add_u32 s25, s25, s40
    ds_read_b128 v[128:131], v13 offset:24576
    ds_read_b128 v[132:135], v13 offset:26624
    ds_read_b64_tr_b16 v[144:145], v15 offset:24576
    ds_read_b64_tr_b16 v[146:147], v15 offset:25088
    ds_read_b64_tr_b16 v[148:149], v16 offset:24576
    ds_read_b64_tr_b16 v[150:151], v16 offset:25088
    ds_read_b64_tr_b16 v[152:153], v15 offset:32768
    ds_read_b64_tr_b16 v[154:155], v15 offset:33280
    ds_read_b64_tr_b16 v[156:157], v16 offset:32768
    ds_read_b64_tr_b16 v[158:159], v16 offset:33280
    ds_read_b128 v[160:163], v14 offset:24576
    ds_read_b128 v[164:167], v14 offset:26624
    ds_read_b64_tr_b16 v[176:177], v15 offset:28672
    ds_read_b64_tr_b16 v[178:179], v15 offset:29184
    ds_read_b64_tr_b16 v[180:181], v16 offset:28672
    ds_read_b64_tr_b16 v[182:183], v16 offset:29184
    ds_read_b64_tr_b16 v[184:185], v15 offset:36864
    ds_read_b64_tr_b16 v[186:187], v15 offset:37376
    ds_read_b64_tr_b16 v[188:189], v16 offset:36864
    ds_read_b64_tr_b16 v[190:191], v16 offset:37376
    s_waitcnt lgkmcnt(10)
    v_mfma_f32_16x16x32_bf16 v[64:67], v[144:147], v[128:131], v[64:67]
    v_mfma_f32_16x16x32_bf16 v[68:71], v[144:147], v[132:135], v[68:71]
    v_mfma_f32_16x16x32_bf16 v[72:75], v[148:151], v[128:131], v[72:75]
    v_mfma_f32_16x16x32_bf16 v[76:79], v[148:151], v[132:135], v[76:79]
    v_mfma_f32_16x16x32_bf16 v[80:83], v[152:155], v[128:131], v[80:83]
    v_mfma_f32_16x16x32_bf16 v[84:87], v[152:155], v[132:135], v[84:87]
    v_mfma_f32_16x16x32_bf16 v[88:91], v[156:159], v[128:131], v[88:91]
    v_mfma_f32_16x16x32_bf16 v[92:95], v[156:159], v[132:135], v[92:95]
    s_waitcnt lgkmcnt(0)
    v_mfma_f32_16x16x32_bf16 v[64:67], v[176:179], v[160:163], v[64:67]
    v_mfma_f32_16x16x32_bf16 v[68:71], v[176:179], v[164:167], v[68:71]
    v_mfma_f32_16x16x32_bf16 v[72:75], v[180:183], v[160:163], v[72:75]
    v_mfma_f32_16x16x32_bf16 v[76:79], v[180:183], v[164:167], v[76:79]
    v_mfma_f32_16x16x32_bf16 v[80:83], v[184:187], v[160:163], v[80:83]
    v_mfma_f32_16x16x32_bf16 v[84:87], v[184:187], v[164:167], v[84:87]
    v_mfma_f32_16x16x32_bf16 v[88:91], v[188:191], v[160:163], v[88:91]
    v_mfma_f32_16x16x32_bf16 v[92:95], v[188:191], v[164:167], v[92:95]
    s_sub_u32 s26, s26, 1
    s_cmp_eq_u32 s26, 0
    s_cbranch_scc1 k2_done
    s_waitcnt vmcnt(6)
    s_barrier
    s_add_u32 m0, s38, 24576
    s_add_u32 s27, s24, 0
    buffer_load_dwordx4 v10, s[8:11], s27 offen lds
    s_add_u32 m0, s38, 25600
    s_add_u32 s27, s24, 27648
    buffer_load_dwordx4 v10, s[8:11], s27 offen lds
    s_add_u32 m0, s39, 24576
    s_add_u32 s27, s25, s32
    buffer_load_dwordx4 v11, s[12:15], s27 offen lds
    s_add_u32 m0, s39, 25600
    s_add_u32 s27, s25, s32
    buffer_load_dwordx4 v12, s[12:15], s27 offen lds
    s_add_u32 m0, s39, 32768
    s_add_u32 s27, s25, s33
    buffer_load_dwordx4 v11, s[16:19], s27 offen lds
    s_add_u32 m0, s39, 33792
    s_add_u32 s27, s25, s33
    buffer_load_dwordx4 v12, s[16:19], s27 offen lds
    s_add_u32 s24, s24, 128
    s_add_u32 s25, s25, s40
    ds_read_b128 v[128:131], v13 offset:49152
    ds_read_b128 v[132:135], v13 offset:51200
    ds_read_b64_tr_b16 v[144:145], v15 offset:49152
    ds_read_b64_tr_b16 v[146:147], v15 offset:49664
    ds_read_b64_tr_b16 v[148:149], v16 offset:49152
    ds_read_b64_tr_b16 v[150:151], v16 offset:49664
    ds_read_b64_tr_b16 v[152:153], v15 offset:57344
    ds_read_b64_tr_b16 v[154:155], v15 offset:57856
    ds_read_b64_tr_b16 v[156:157], v16 offset:57344
    ds_read_b64_tr_b16 v[158:159], v16 offset:57856
    ds_read_b128 v[160:163], v14 offset:49152
    ds_read_b128 v[164:167], v14 offset:51200
    ds_read_b64_tr_b16 v[176:177], v15 offset:53248
    ds_read_b64_tr_b16 v[178:179], v15 offset:53760
    ds_read_b64_tr_b16 v[180:181], v16 offset:53248
    ds_read_b64_tr_b16 v[182:183], v16 offset:53760
    ds_read_b64_tr_b16 v[184:185], v15 offset:61440
    ds_read_b64_tr_b16 v[186:187], v15 offset:61952
    ds_read_b64_tr_b16 v[188:189], v16 offset:61440
    ds_read_b64_tr_b16 v[190:191], v16 offset:61952
    s_waitcnt lgkmcnt(10)
    v_mfma_f32_16x16x32_bf16 v[64:67], v[144:147], v[128:131], v[64:67]
    v_mfma_f32_16x16x32_bf16 v[68:71], v[144:147], v[132:135], v[68:71]
    v_mfma_f32_16x16x32_bf16 v[72:75], v[148:151], v[128:131], v[72:75]
    v_mfma_f32_16x16x32_bf16 v[76:79], v[148:151], v[132:135], v[76:79]
    v_mfma_f32_16x16x32_bf16 v[80:83], v[152:155], v[128:131], v[80:83]
    v_mfma_f32_16x16x32_bf16 v[84:87], v[152:155], v[132:135], v[84:87]
    v_mfma_f32_16x16x32_bf16 v[88:91], v[156:159], v[128:131], v[88:91]
    v_mfma_f32_16x16x32_bf16 v[92:95], v[156:159], v[132:135], v[92:95]
    s_waitcnt lgkmcnt(0)
    v_mfma_f32_16x16x32_bf16 v[64:67], v[176:179], v[160:163], v[64:67]
    v_mfma_f32_16x16x32_bf16 v[68:71], v[176:179], v[164:167], v[68:71]
    v_mfma_f32_16x16x32_bf16 v[72:75], v[180:183], v[160:163], v[72:75]
    v_mfma_f32_16x16x32_bf16 v[76:79], v[180:183], v[164:167], v[76:79]
    v_mfma_f32_16x16x32_bf16 v[80:83], v[184:187], v[160:163], v[80:83]
    v_mfma_f32_16x16x32_bf16 v[84:87], v[184:187], v[164:167], v[84:87]
    v_mfma_f32_16x16x32_bf16 v[88:91], v[188:191], v[160:163], v[88:91]
    v_mfma_f32_16x16x32_bf16 v[92:95], v[188:191], v[164:167], v[92:95]
    s_sub_u32 s26, s26, 1
    s_cmp_eq_u32 s26, 0
    s_cbranch_scc1 k2_done
    s_branch k2_loop
k2_done:
    s_nop 15
    s_lshl_b32 s27, s41, 6
    s_lshl_b32 s43, s34, 5
    s_add_u32 s27, s27, s43
    v_add_u32 v6, s27, v3
    v_mul_u32_u24 v5, 1280, v6
    v_lshl_add_u32 v5, v4, 3, v5
    s_lshl_b32 s27, s35, 6
    s_add_u32 s27, s27, s32
    v_add_u32 v5, s27, v5
    v_add_u32 v5, 17563648, v5
    v_cvt_pk_bf16_f32 v128, v64, v65
    v_cvt_pk_bf16_f32 v129, v66, v67
    s_mov_b32 s27, 0
    buffer_store_dwordx2 v[128:129], v5, s[20:23], s27 offen
    v_cvt_pk_bf16_f32 v130, v68, v69
    v_cvt_pk_bf16_f32 v131, v70, v71
    s_mov_b32 s27, 20480
    buffer_store_dwordx2 v[130:131], v5, s[20:23], s27 offen
    v_cvt_pk_bf16_f32 v132, v72, v73
    v_cvt_pk_bf16_f32 v133, v74, v75
    s_mov_b32 s27, 32
    buffer_store_dwordx2 v[132:133], v5, s[20:23], s27 offen
    v_cvt_pk_bf16_f32 v134, v76, v77
    v_cvt_pk_bf16_f32 v135, v78, v79
    s_mov_b32 s27, 20512
    buffer_store_dwordx2 v[134:135], v5, s[20:23], s27 offen
    v_cvt_pk_bf16_f32 v136, v80, v81
    v_cvt_pk_bf16_f32 v137, v82, v83
    s_mov_b32 s27, 128
    buffer_store_dwordx2 v[136:137], v5, s[20:23], s27 offen
    v_cvt_pk_bf16_f32 v138, v84, v85
    v_cvt_pk_bf16_f32 v139, v86, v87
    s_mov_b32 s27, 20608
    buffer_store_dwordx2 v[138:139], v5, s[20:23], s27 offen
    v_cvt_pk_bf16_f32 v140, v88, v89
    v_cvt_pk_bf16_f32 v141, v90, v91
    s_mov_b32 s27, 160
    buffer_store_dwordx2 v[140:141], v5, s[20:23], s27 offen
    v_cvt_pk_bf16_f32 v142, v92, v93
    v_cvt_pk_bf16_f32 v143, v94, v95
    s_mov_b32 s27, 20640
    buffer_store_dwordx2 v[142:143], v5, s[20:23], s27 offen
    s_branch k2_end
k2_att:
    s_sub_u32 s27, s2, 160
    s_and_b32 s41, s27, 31
    s_lshr_b32 s42, s27, 5
    v_lshrrev_b32 v1, 6, v0
    v_and_b32 v2, 63, v0
    s_nop 0
    v_readfirstlane_b32 s36, v1
    s_lshl_b32 s43, s42, 11
    s_lshl_b32 s27, s41, 6
    s_add_u32 s43, s43, s27
    s_mul_i32 s24, s43, 40
    s_add_u32 s24, s24, 2611200
    v_lshlrev_b32 v3, 4, v2
    s_lshl_b32 s27, s36, 10
    s_add_u32 s27, s27, 0
    s_add_u32 m0, s27, 0
    s_add_u32 s27, s27, s24
    s_add_u32 s27, s27, 0
    buffer_load_dwordx4 v3, s[20:23], s27 offen lds
    s_lshl_b32 s27, s36, 10
    s_add_u32 s27, s27, 4096
    s_add_u32 m0, s27, 0
    s_add_u32 s27, s27, s24
    s_add_u32 s27, s27, 0
    buffer_load_dwordx4 v3, s[20:23], s27 offen lds
    s_lshl_b32 s27, s36, 10
    s_add_u32 s27, s27, 8192
    s_add_u32 m0, s27, 0
    s_add_u32 s27, s27, s24
    s_add_u32 s27, s27, 0
    buffer_load_dwordx4 v3, s[20:23], s27 offen lds
    s_cmp_lg_u32 s36, 0
    s_cbranch_scc1 k2_sk0
    s_lshl_b32 s27, s36, 10
    s_add_u32 s27, s27, 12288
    s_add_u32 m0, s27, 0
    s_add_u32 s27, s27, s24
    s_add_u32 s27, s27, 0
    buffer_load_dwordx4 v3, s[20:23], s27 offen lds
k2_sk0:
    s_lshl_b32 s27, s36, 10
    s_add_u32 s27, s27, 0
    s_add_u32 m0, s27, 13312
    s_add_u32 s27, s27, s24
    s_add_u32 s27, s27, 2621440
    buffer_load_dwordx4 v3, s[20:23], s27 offen lds
    s_lshl_b32 s27, s36, 10
    s_add_u32 s27, s27, 4096
    s_add_u32 m0, s27, 13312
    s_add_u32 s27, s27, s24
    s_add_u32 s27, s27, 2621440
    buffer_load_dwordx4 v3, s[20:23], s27 offen lds
    s_lshl_b32 s27, s36, 10
    s_add_u32 s27, s27, 8192
    s_add_u32 m0, s27, 13312
    s_add_u32 s27, s27, s24
    s_add_u32 s27, s27, 2621440
    buffer_load_dwordx4 v3, s[20:23], s27 offen lds
    s_cmp_lg_u32 s36, 0
    s_cbranch_scc1 k2_sk1
    s_lshl_b32 s27, s36, 10
    s_add_u32 s27, s27, 12288
    s_add_u32 m0, s27, 13312
    s_add_u32 s27, s27, s24
    s_add_u32 s27, s27, 2621440
    buffer_load_dwordx4 v3, s[20:23], s27 offen lds
k2_sk1:
    v_and_b32 v3, 15, v2
    v_lshrrev_b32 v4, 4, v2
    s_lshl_b32 s27, s36, 4
    s_add_u32 s43, s43, s27
    v_add_u32 v5, s43, v3
    v_mul_u32_u24 v5, 40, v5
    v_lshl_add_u32 v5, v4, 4, v5
    buffer_load_dwordx4 v[8:11], v5, s[20:23], 0 offen
    s_mul_i32 s27, s36, 640
    v_mul_u32_u24 v6, 40, v3
    v_lshl_add_u32 v6, v4, 4, v6
    v_add_u32 v6, s27, v6
    v_lshrrev_b32 v7, 2, v3
    v_lshl_add_u32 v7, v4, 2, v7
    v_mul_u32_u24 v7, 40, v7
    v_and_b32 v12, 3, v3
    v_lshl_add_u32 v7, v12, 3, v7
    v_add_u32 v7, s27, v7
    v_add_u32 v7, 13312, v7
    v_cmp_gt_u32 vcc, 3, v4
    v_cmp_gt_u32 s[28:29], 2, v4
    s_waitcnt vmcnt(0)
    s_barrier
    v_cndmask_b32 v8, 0, v8, vcc
    v_cndmask_b32 v9, 0, v9, vcc
    v_cndmask_b32 v10, 0, v10, s[28:29]
    v_cndmask_b32 v11, 0, v11, s[28:29]
    ds_read_b64 v[132:133], v6 offset:0
    ds_read_b64 v[134:135], v6 offset:8
    ds_read_b64 v[136:137], v6 offset:640
    ds_read_b64 v[138:139], v6 offset:648
    ds_read_b64 v[140:141], v6 offset:1280
    ds_read_b64 v[142:143], v6 offset:1288
    ds_read_b64 v[144:145], v6 offset:1920
    ds_read_b64 v[146:147], v6 offset:1928
    ds_read_b64 v[148:149], v6 offset:2560
    ds_read_b64 v[150:151], v6 offset:2568
    ds_read_b64 v[152:153], v6 offset:3200
    ds_read_b64 v[154:155], v6 offset:3208
    ds_read_b64 v[156:157], v6 offset:3840
    ds_read_b64 v[158:159], v6 offset:3848
    ds_read_b64 v[160:161], v6 offset:4480
    ds_read_b64 v[162:163], v6 offset:4488
    ds_read_b64 v[164:165], v6 offset:5120
    ds_read_b64 v[166:167], v6 offset:5128
    ds_read_b64 v[168:169], v6 offset:5760
    ds_read_b64 v[170:171], v6 offset:5768
    ds_read_b64 v[172:173], v6 offset:6400
    ds_read_b64 v[174:175], v6 offset:6408
    ds_read_b64 v[176:177], v6 offset:7040
    ds_read_b64 v[178:179], v6 offset:7048
    ds_read_b64 v[180:181], v6 offset:7680
    ds_read_b64 v[182:183], v6 offset:7688
    ds_read_b64 v[184:185], v6 offset:8320
    ds_read_b64 v[186:187], v6 offset:8328
    ds_read_b64 v[188:189], v6 offset:8960
    ds_read_b64 v[190:191], v6 offset:8968
    ds_read_b64 v[192:193], v6 offset:9600
    ds_read_b64 v[194:195], v6 offset:9608
    ds_read_b64 v[196:197], v6 offset:10240
    ds_read_b64 v[198:199], v6 offset:10248
    s_waitcnt lgkmcnt(15)
    v_mfma_f32_16x16x32_bf16 v[64:67], v[132:135], v[8:11], 0
    s_waitcnt lgkmcnt(15)
    v_mfma_f32_16x16x32_bf16 v[68:71], v[136:139], v[8:11], 0
    s_waitcnt lgkmcnt(15)
    v_mfma_f32_16x16x32_bf16 v[72:75], v[140:143], v[8:11], 0
    s_waitcnt lgkmcnt(15)
    v_mfma_f32_16x16x32_bf16 v[76:79], v[144:147], v[8:11], 0
    s_waitcnt lgkmcnt(15)
    v_mfma_f32_16x16x32_bf16 v[80:83], v[148:151], v[8:11], 0
    s_waitcnt lgkmcnt(15)
    v_mfma_f32_16x16x32_bf16 v[84:87], v[152:155], v[8:11], 0
    s_waitcnt lgkmcnt(15)
    v_mfma_f32_16x16x32_bf16 v[88:91], v[156:159], v[8:11], 0
    s_waitcnt lgkmcnt(15)
    v_mfma_f32_16x16x32_bf16 v[92:95], v[160:163], v[8:11], 0
    s_waitcnt lgkmcnt(15)
    v_mfma_f32_16x16x32_bf16 v[96:99], v[164:167], v[8:11], 0
    s_waitcnt lgkmcnt(14)
    v_mfma_f32_16x16x32_bf16 v[100:103], v[168:171], v[8:11], 0
    s_waitcnt lgkmcnt(12)
    v_mfma_f32_16x16x32_bf16 v[104:107], v[172:175], v[8:11], 0
    s_waitcnt lgkmcnt(10)
    v_mfma_f32_16x16x32_bf16 v[108:111], v[176:179], v[8:11], 0
    s_waitcnt lgkmcnt(8)
    v_mfma_f32_16x16x32_bf16 v[112:115], v[180:183], v[8:11], 0
    s_waitcnt lgkmcnt(6)
    v_mfma_f32_16x16x32_bf16 v[116:119], v[184:187], v[8:11], 0
    s_waitcnt lgkmcnt(4)
    v_mfma_f32_16x16x32_bf16 v[120:123], v[188:191], v[8:11], 0
    s_waitcnt lgkmcnt(2)
    v_mfma_f32_16x16x32_bf16 v[124:127], v[192:195], v[8:11], 0
    s_waitcnt lgkmcnt(0)
    v_mfma_f32_16x16x32_bf16 v[128:131], v[196:199], v[8:11], 0
    v_lshlrev_b32 v12, 2, v4
    v_mov_b32 v13, 0xf149f2ca
    s_nop 7
    v_add_u32 v14, 0, v12
    v_cmp_gt_u32 vcc, v14, v3
    s_nop 1
    v_cndmask_b32 v64, v13, v64, vcc
    v_cndmask_b32 v128, v128, v13, vcc
    v_add_u32 v14, 1, v12
    v_cmp_gt_u32 vcc, v14, v3
    s_nop 1
    v_cndmask_b32 v65, v13, v65, vcc
    v_cndmask_b32 v129, v129, v13, vcc
    v_add_u32 v14, 2, v12
    v_cmp_gt_u32 vcc, v14, v3
    s_nop 1
    v_cndmask_b32 v66, v13, v66, vcc
    v_cndmask_b32 v130, v130, v13, vcc
    v_add_u32 v14, 3, v12
    v_cmp_gt_u32 vcc, v14, v3
    s_nop 1
    v_cndmask_b32 v67, v13, v67, vcc
    v_cndmask_b32 v131, v131, v13, vcc
    s_lshl_b32 s27, s41, 2
    s_add_u32 s27, s27, s36
    s_cmp_ge_u32 s27, 16
    s_cbranch_scc1 k2_nm
    s_add_u32 s26, s27, 0
    s_cmp_lt_u32 s26, 16
    s_cselect_b64 s[28:29], -1, 0
    v_cndmask_b32 v64, v64, v13, s[28:29]
    v_cndmask_b32 v65, v65, v13, s[28:29]
    v_cndmask_b32 v66, v66, v13, s[28:29]
    v_cndmask_b32 v67, v67, v13, s[28:29]
    s_add_u32 s26, s27, 1
    s_cmp_lt_u32 s26, 16
    s_cselect_b64 s[28:29], -1, 0
    v_cndmask_b32 v68, v68, v13, s[28:29]
    v_cndmask_b32 v69, v69, v13, s[28:29]
    v_cndmask_b32 v70, v70, v13, s[28:29]
    v_cndmask_b32 v71, v71, v13, s[28:29]
    s_add_u32 s26, s27, 2
    s_cmp_lt_u32 s26, 16
    s_cselect_b64 s[28:29], -1, 0
    v_cndmask_b32 v72, v72, v13, s[28:29]
    v_cndmask_b32 v73, v73, v13, s[28:29]
    v_cndmask_b32 v74, v74, v13, s[28:29]
    v_cndmask_b32 v75, v75, v13, s[28:29]
    s_add_u32 s26, s27, 3
    s_cmp_lt_u32 s26, 16
    s_cselect_b64 s[28:29], -1, 0
    v_cndmask_b32 v76, v76, v13, s[28:29]
    v_cndmask_b32 v77, v77, v13, s[28:29]
    v_cndmask_b32 v78, v78, v13, s[28:29]
    v_cndmask_b32 v79, v79, v13, s[28:29]
    s_add_u32 s26, s27, 4
    s_cmp_lt_u32 s26, 16
    s_cselect_b64 s[28:29], -1, 0
    v_cndmask_b32 v80, v80, v13, s[28:29]
    v_cndmask_b32 v81, v81, v13, s[28:29]
    v_cndmask_b32 v82, v82, v13, s[28:29]
    v_cndmask_b32 v83, v83, v13, s[28:29]
    s_add_u32 s26, s27, 5
    s_cmp_lt_u32 s26, 16
    s_cselect_b64 s[28:29], -1, 0
    v_cndmask_b32 v84, v84, v13, s[28:29]
    v_cndmask_b32 v85, v85, v13, s[28:29]
    v_cndmask_b32 v86, v86, v13, s[28:29]
    v_cndmask_b32 v87, v87, v13, s[28:29]
    s_add_u32 s26, s27, 6
    s_cmp_lt_u32 s26, 16
    s_cselect_b64 s[28:29], -1, 0
    v_cndmask_b32 v88, v88, v13, s[28:29]
    v_cndmask_b32 v89, v89, v13, s[28:29]
    v_cndmask_b32 v90, v90, v13, s[28:29]
    v_cndmask_b32 v91, v91, v13, s[28:29]
    s_add_u32 s26, s27, 7
    s_cmp_lt_u32 s26, 16
    s_cselect_b64 s[28:29], -1, 0
    v_cndmask_b32 v92, v92, v13, s[28:29]
    v_cndmask_b32 v93, v93, v13, s[28:29]
    v_cndmask_b32 v94, v94, v13, s[28:29]
    v_cndmask_b32 v95, v95, v13, s[28:29]
    s_add_u32 s26, s27, 8
    s_cmp_lt_u32 s26, 16
    s_cselect_b64 s[28:29], -1, 0
    v_cndmask_b32 v96, v96, v13, s[28:29]
    v_cndmask_b32 v97, v97, v13, s[28:29]
    v_cndmask_b32 v98, v98, v13, s[28:29]
    v_cndmask_b32 v99, v99, v13, s[28:29]
    s_add_u32 s26, s27, 9
    s_cmp_lt_u32 s26, 16
    s_cselect_b64 s[28:29], -1, 0
    v_cndmask_b32 v100, v100, v13, s[28:29]
    v_cndmask_b32 v101, v101, v13, s[28:29]
    v_cndmask_b32 v102, v102, v13, s[28:29]
    v_cndmask_b32 v103, v103, v13, s[28:29]
    s_add_u32 s26, s27, 10
    s_cmp_lt_u32 s26, 16
    s_cselect_b64 s[28:29], -1, 0
    v_cndmask_b32 v104, v104, v13, s[28:29]
    v_cndmask_b32 v105, v105, v13, s[28:29]
    v_cndmask_b32 v106, v106, v13, s[28:29]
    v_cndmask_b32 v107, v107, v13, s[28:29]
    s_add_u32 s26, s27, 11
    s_cmp_lt_u32 s26, 16
    s_cselect_b64 s[28:29], -1, 0
    v_cndmask_b32 v108, v108, v13, s[28:29]
    v_cndmask_b32 v109, v109, v13, s[28:29]
    v_cndmask_b32 v110, v110, v13, s[28:29]
    v_cndmask_b32 v111, v111, v13, s[28:29]
    s_add_u32 s26, s27, 12
    s_cmp_lt_u32 s26, 16
    s_cselect_b64 s[28:29], -1, 0
    v_cndmask_b32 v112, v112, v13, s[28:29]
    v_cndmask_b32 v113, v113, v13, s[28:29]
    v_cndmask_b32 v114, v114, v13, s[28:29]
    v_cndmask_b32 v115, v115, v13, s[28:29]
    s_add_u32 s26, s27, 13
    s_cmp_lt_u32 s26, 16
    s_cselect_b64 s[28:29], -1, 0
    v_cndmask_b32 v116, v116, v13, s[28:29]
    v_cndmask_b32 v117, v117, v13, s[28:29]
    v_cndmask_b32 v118, v118, v13, s[28:29]
    v_cndmask_b32 v119, v119, v13, s[28:29]
    s_add_u32 s26, s27, 14
    s_cmp_lt_u32 s26, 16
    s_cselect_b64 s[28:29], -1, 0
    v_cndmask_b32 v120, v120, v13, s[28:29]
    v_cndmask_b32 v121, v121, v13, s[28:29]
    v_cndmask_b32 v122, v122, v13, s[28:29]
    v_cndmask_b32 v123, v123, v13, s[28:29]
    s_add_u32 s26, s27, 15
    s_cmp_lt_u32 s26, 16
    s_cselect_b64 s[28:29], -1, 0
    v_cndmask_b32 v124, v124, v13, s[28:29]
    v_cndmask_b32 v125, v125, v13, s[28:29]
    v_cndmask_b32 v126, v126, v13, s[28:29]
    v_cndmask_b32 v127, v127, v13, s[28:29]
k2_nm:
    v_max3_f32 v14, v64, v65, v66
    v_max3_f32 v14, v14, v67, v68
    v_max3_f32 v14, v14, v69, v70
    v_max3_f32 v14, v14, v71, v72
    v_max3_f32 v14, v14, v73, v74
    v_max3_f32 v14, v14, v75, v76
    v_max3_f32 v14, v14, v77, v78
    v_max3_f32 v14, v14, v79, v80
    v_max3_f32 v14, v14, v81, v82
    v_max3_f32 v14, v14, v83, v84
    v_max3_f32 v14, v14, v85, v86
    v_max3_f32 v14, v14, v87, v88
    v_max3_f32 v14, v14, v89, v90
    v_max3_f32 v14, v14, v91, v92
    v_max3_f32 v14, v14, v93, v94
    v_max3_f32 v14, v14, v95, v96
    v_max3_f32 v14, v14, v97, v98
    v_max3_f32 v14, v14, v99, v100
    v_max3_f32 v14, v14, v101, v102
    v_max3_f32 v14, v14, v103, v104
    v_max3_f32 v14, v14, v105, v106
    v_max3_f32 v14, v14, v107, v108
    v_max3_f32 v14, v14, v109, v110
    v_max3_f32 v14, v14, v111, v112
    v_max3_f32 v14, v14, v113, v114
    v_max3_f32 v14, v14, v115, v116
    v_max3_f32 v14, v14, v117, v118
    v_max3_f32 v14, v14, v119, v120
    v_max3_f32 v14, v14, v121, v122
    v_max3_f32 v14, v14, v123, v124
    v_max3_f32 v14, v14, v125, v126
    v_max3_f32 v14, v14, v127, v128
    v_max3_f32 v14, v14, v129, v130
    v_max_f32 v14, v14, v131
    v_xor_b32 v15, 16, v2
    v_lshlrev_b32 v15, 2, v15
    v_xor_b32 v16, 32, v2
    v_lshlrev_b32 v16, 2, v16
    ds_bpermute_b32 v17, v15, v14
    s_waitcnt lgkmcnt(0)
    v_max_f32 v14, v14, v17
    ds_bpermute_b32 v17, v16, v14
    s_waitcnt lgkmcnt(0)
    v_max_f32 v14, v14, v17
    s_mov_b32 s27, 0x3ea52ba0
    v_mul_f32 v14, s27, v14
    v_mov_b32 v18, 0
    v_fma_f32 v64, v64, s27, -v14
    v_fma_f32 v65, v65, s27, -v14
    v_fma_f32 v66, v66, s27, -v14
    v_fma_f32 v67, v67, s27, -v14
    v_fma_f32 v68, v68, s27, -v14
    v_fma_f32 v69, v69, s27, -v14
    v_fma_f32 v70, v70, s27, -v14
    v_fma_f32 v71, v71, s27, -v14
    v_fma_f32 v72, v72, s27, -v14
    v_fma_f32 v73, v73, s27, -v14
    v_fma_f32 v74, v74, s27, -v14
    v_fma_f32 v75, v75, s27, -v14
    v_fma_f32 v76, v76, s27, -v14
    v_fma_f32 v77, v77, s27, -v14
    v_fma_f32 v78, v78, s27, -v14
    v_fma_f32 v79, v79, s27, -v14
    v_fma_f32 v80, v80, s27, -v14
    v_fma_f32 v81, v81, s27, -v14
    v_fma_f32 v82, v82, s27, -v14
    v_fma_f32 v83, v83, s27, -v14
    v_fma_f32 v84, v84, s27, -v14
    v_fma_f32 v85, v85, s27, -v14
    v_fma_f32 v86, v86, s27, -v14
    v_fma_f32 v87, v87, s27, -v14
    v_fma_f32 v88, v88, s27, -v14
    v_fma_f32 v89, v89, s27, -v14
    v_fma_f32 v90, v90, s27, -v14
    v_fma_f32 v91, v91, s27, -v14
    v_fma_f32 v92, v92, s27, -v14
    v_fma_f32 v93, v93, s27, -v14
    v_fma_f32 v94, v94, s27, -v14
    v_fma_f32 v95, v95, s27, -v14
    v_fma_f32 v96, v96, s27, -v14
    v_fma_f32 v97, v97, s27, -v14
    v_fma_f32 v98, v98, s27, -v14
    v_fma_f32 v99, v99, s27, -v14
    v_fma_f32 v100, v100, s27, -v14
    v_fma_f32 v101, v101, s27, -v14
    v_fma_f32 v102, v102, s27, -v14
    v_fma_f32 v103, v103, s27, -v14
    v_fma_f32 v104, v104, s27, -v14
    v_fma_f32 v105, v105, s27, -v14
    v_fma_f32 v106, v106, s27, -v14
    v_fma_f32 v107, v107, s27, -v14
    v_fma_f32 v108, v108, s27, -v14
    v_fma_f32 v109, v109, s27, -v14
    v_fma_f32 v110, v110, s27, -v14
    v_fma_f32 v111, v111, s27, -v14
    v_fma_f32 v112, v112, s27, -v14
    v_fma_f32 v113, v113, s27, -v14
    v_fma_f32 v114, v114, s27, -v14
    v_fma_f32 v115, v115, s27, -v14
    v_fma_f32 v116, v116, s27, -v14
    v_fma_f32 v117, v117, s27, -v14
    v_fma_f32 v118, v118, s27, -v14
    v_fma_f32 v119, v119, s27, -v14
    v_fma_f32 v120, v120, s27, -v14
    v_fma_f32 v121, v121, s27, -v14
    v_fma_f32 v122, v122, s27, -v14
    v_fma_f32 v123, v123, s27, -v14
    v_fma_f32 v124, v124, s27, -v14
    v_fma_f32 v125, v125, s27, -v14
    v_fma_f32 v126, v126, s27, -v14
    v_fma_f32 v127, v127, s27, -v14
    v_fma_f32 v128, v128, s27, -v14
    v_fma_f32 v129, v129, s27, -v14
    v_fma_f32 v130, v130, s27, -v14
    v_fma_f32 v131, v131, s27, -v14
    v_exp_f32 v64, v64
    v_exp_f32 v65, v65
    v_exp_f32 v66, v66
    v_exp_f32 v67, v67
    v_exp_f32 v68, v68
    v_exp_f32 v69, v69
    v_exp_f32 v70, v70
    v_exp_f32 v71, v71
    v_exp_f32 v72, v72
    v_exp_f32 v73, v73
    v_exp_f32 v74, v74
    v_exp_f32 v75, v75
    v_exp_f32 v76, v76
    v_exp_f32 v77, v77
    v_exp_f32 v78, v78
    v_exp_f32 v79, v79
    v_exp_f32 v80, v80
    v_exp_f32 v81, v81
    v_exp_f32 v82, v82
    v_exp_f32 v83, v83
    v_exp_f32 v84, v84
    v_exp_f32 v85, v85
    v_exp_f32 v86, v86
    v_exp_f32 v87, v87
    v_exp_f32 v88, v88
    v_exp_f32 v89, v89
    v_exp_f32 v90, v90
    v_exp_f32 v91, v91
    v_exp_f32 v92, v92
    v_exp_f32 v93, v93
    v_exp_f32 v94, v94
    v_exp_f32 v95, v95
    v_exp_f32 v96, v96
    v_exp_f32 v97, v97
    v_exp_f32 v98, v98
    v_exp_f32 v99, v99
    v_exp_f32 v100, v100
    v_exp_f32 v101, v101
    v_exp_f32 v102, v102
    v_exp_f32 v103, v103
    v_exp_f32 v104, v104
    v_exp_f32 v105, v105
    v_exp_f32 v106, v106
    v_exp_f32 v107, v107
    v_exp_f32 v108, v108
    v_exp_f32 v109, v109
    v_exp_f32 v110, v110
    v_exp_f32 v111, v111
    v_exp_f32 v112, v112
    v_exp_f32 v113, v113
    v_exp_f32 v114, v114
    v_exp_f32 v115, v115
    v_exp_f32 v116, v116
    v_exp_f32 v117, v117
    v_exp_f32 v118, v118
    v_exp_f32 v119, v119
    v_exp_f32 v120, v120
    v_exp_f32 v121, v121
    v_exp_f32 v122, v122
    v_exp_f32 v123, v123
    v_exp_f32 v124, v124
    v_exp_f32 v125, v125
    v_exp_f32 v126, v126
    v_exp_f32 v127, v127
    v_exp_f32 v128, v128
    v_exp_f32 v129, v129
    v_exp_f32 v130, v130
    v_exp_f32 v131, v131
    s_nop 0
    v_add_f32 v18, v18, v64
    v_add_f32 v18, v18, v65
    v_add_f32 v18, v18, v66
    v_add_f32 v18, v18, v67
    v_add_f32 v18, v18, v68
    v_add_f32 v18, v18, v69
    v_add_f32 v18, v18, v70
    v_add_f32 v18, v18, v71
    v_add_f32 v18, v18, v72
    v_add_f32 v18, v18, v73
    v_add_f32 v18, v18, v74
    v_add_f32 v18, v18, v75
    v_add_f32 v18, v18, v76
    v_add_f32 v18, v18, v77
    v_add_f32 v18, v18, v78
    v_add_f32 v18, v18, v79
    v_add_f32 v18, v18, v80
    v_add_f32 v18, v18, v81
    v_add_f32 v18, v18, v82
    v_add_f32 v18, v18, v83
    v_add_f32 v18, v18, v84
    v_add_f32 v18, v18, v85
    v_add_f32 v18, v18, v86
    v_add_f32 v18, v18, v87
    v_add_f32 v18, v18, v88
    v_add_f32 v18, v18, v89
    v_add_f32 v18, v18, v90
    v_add_f32 v18, v18, v91
    v_add_f32 v18, v18, v92
    v_add_f32 v18, v18, v93
    v_add_f32 v18, v18, v94
    v_add_f32 v18, v18, v95
    v_add_f32 v18, v18, v96
    v_add_f32 v18, v18, v97
    v_add_f32 v18, v18, v98
    v_add_f32 v18, v18, v99
    v_add_f32 v18, v18, v100
    v_add_f32 v18, v18, v101
    v_add_f32 v18, v18, v102
    v_add_f32 v18, v18, v103
    v_add_f32 v18, v18, v104
    v_add_f32 v18, v18, v105
    v_add_f32 v18, v18, v106
    v_add_f32 v18, v18, v107
    v_add_f32 v18, v18, v108
    v_add_f32 v18, v18, v109
    v_add_f32 v18, v18, v110
    v_add_f32 v18, v18, v111
    v_add_f32 v18, v18, v112
    v_add_f32 v18, v18, v113
    v_add_f32 v18, v18, v114
    v_add_f32 v18, v18, v115
    v_add_f32 v18, v18, v116
    v_add_f32 v18, v18, v117
    v_add_f32 v18, v18, v118
    v_add_f32 v18, v18, v119
    v_add_f32 v18, v18, v120
    v_add_f32 v18, v18, v121
    v_add_f32 v18, v18, v122
    v_add_f32 v18, v18, v123
    v_add_f32 v18, v18, v124
    v_add_f32 v18, v18, v125
    v_add_f32 v18, v18, v126
    v_add_f32 v18, v18, v127
    v_add_f32 v18, v18, v128
    v_add_f32 v18, v18, v129
    v_add_f32 v18, v18, v130
    v_add_f32 v18, v18, v131
    v_cvt_pk_bf16_f32 v132, v64, v65
    v_cvt_pk_bf16_f32 v133, v66, v67
    v_cvt_pk_bf16_f32 v134, v68, v69
    v_cvt_pk_bf16_f32 v135, v70, v71
    v_cvt_pk_bf16_f32 v136, v72, v73
    v_cvt_pk_bf16_f32 v137, v74, v75
    v_cvt_pk_bf16_f32 v138, v76, v77
    v_cvt_pk_bf16_f32 v139, v78, v79
    v_cvt_pk_bf16_f32 v140, v80, v81
    v_cvt_pk_bf16_f32 v141, v82, v83
    v_cvt_pk_bf16_f32 v142, v84, v85
    v_cvt_pk_bf16_f32 v143, v86, v87
    v_cvt_pk_bf16_f32 v144, v88, v89
    v_cvt_pk_bf16_f32 v145, v90, v91
    v_cvt_pk_bf16_f32 v146, v92, v93
    v_cvt_pk_bf16_f32 v147, v94, v95
    v_cvt_pk_bf16_f32 v148, v96, v97
    v_cvt_pk_bf16_f32 v149, v98, v99
    v_cvt_pk_bf16_f32 v150, v100, v101
    v_cvt_pk_bf16_f32 v151, v102, v103
    v_cvt_pk_bf16_f32 v152, v104, v105
    v_cvt_pk_bf16_f32 v153, v106, v107
    v_cvt_pk_bf16_f32 v154, v108, v109
    v_cvt_pk_bf16_f32 v155, v110, v111
    v_cvt_pk_bf16_f32 v156, v112, v113
    v_cvt_pk_bf16_f32 v157, v114, v115
    v_cvt_pk_bf16_f32 v158, v116, v117
    v_cvt_pk_bf16_f32 v159, v118, v119
    v_cvt_pk_bf16_f32 v160, v120, v121
    v_cvt_pk_bf16_f32 v161, v122, v123
    v_cvt_pk_bf16_f32 v162, v124, v125
    v_cvt_pk_bf16_f32 v163, v126, v127
    v_cvt_pk_bf16_f32 v164, v128, v129
    v_cvt_pk_bf16_f32 v165, v130, v131
    ds_bpermute_b32 v17, v15, v18
    s_waitcnt lgkmcnt(0)
    v_add_f32 v18, v18, v17
    ds_bpermute_b32 v17, v16, v18
    s_waitcnt lgkmcnt(0)
    v_add_f32 v18, v18, v17
    v_rcp_f32 v18, v18
    v_mov_b32 v20, 0
    v_mov_b32 v21, 0
    v_mov_b32 v22, 0
    v_mov_b32 v23, 0
    v_mov_b32 v24, 0
    v_mov_b32 v25, 0
    v_mov_b32 v26, 0
    v_mov_b32 v27, 0
    ds_read_b64_tr_b16 v[64:65], v7 offset:0
    ds_read_b64_tr_b16 v[66:67], v7 offset:640
    ds_read_b64_tr_b16 v[68:69], v7 offset:1280
    ds_read_b64_tr_b16 v[70:71], v7 offset:1920
    ds_read_b64_tr_b16 v[72:73], v7 offset:2560
    ds_read_b64_tr_b16 v[74:75], v7 offset:3200
    ds_read_b64_tr_b16 v[76:77], v7 offset:3840
    ds_read_b64_tr_b16 v[78:79], v7 offset:4480
    ds_read_b64_tr_b16 v[80:81], v7 offset:5120
    ds_read_b64_tr_b16 v[82:83], v7 offset:5760
    ds_read_b64_tr_b16 v[84:85], v7 offset:6400
    ds_read_b64_tr_b16 v[86:87], v7 offset:7040
    ds_read_b64_tr_b16 v[88:89], v7 offset:7680
    ds_read_b64_tr_b16 v[90:91], v7 offset:8320
    ds_read_b64_tr_b16 v[92:93], v7 offset:8960
    ds_read_b64_tr_b16 v[94:95], v7 offset:9600
    ds_read_b64_tr_b16 v[96:97], v7 offset:10240
    s_waitcnt lgkmcnt(0)
    v_mfma_f32_16x16x32_bf16 v[20:23], v[64:67], v[132:135], v[20:23]
    v_mfma_f32_16x16x32_bf16 v[20:23], v[68:71], v[136:139], v[20:23]
    v_mfma_f32_16x16x32_bf16 v[20:23], v[72:75], v[140:143], v[20:23]
    v_mfma_f32_16x16x32_bf16 v[20:23], v[76:79], v[144:147], v[20:23]
    v_mfma_f32_16x16x32_bf16 v[20:23], v[80:83], v[148:151], v[20:23]
    v_mfma_f32_16x16x32_bf16 v[20:23], v[84:87], v[152:155], v[20:23]
    v_mfma_f32_16x16x32_bf16 v[20:23], v[88:91], v[156:159], v[20:23]
    v_mfma_f32_16x16x32_bf16 v[20:23], v[92:95], v[160:163], v[20:23]
    s_nop 7
    v_mfma_f32_16x16x16_bf16 v[20:23], v[96:97], v[164:165], v[20:23]
    s_nop 7
    ds_read_b64_tr_b16 v[64:65], v7 offset:32
    ds_read_b64_tr_b16 v[66:67], v7 offset:672
    ds_read_b64_tr_b16 v[68:69], v7 offset:1312
    ds_read_b64_tr_b16 v[70:71], v7 offset:1952
    ds_read_b64_tr_b16 v[72:73], v7 offset:2592
    ds_read_b64_tr_b16 v[74:75], v7 offset:3232
    ds_read_b64_tr_b16 v[76:77], v7 offset:3872
    ds_read_b64_tr_b16 v[78:79], v7 offset:4512
    ds_read_b64_tr_b16 v[80:81], v7 offset:5152
    ds_read_b64_tr_b16 v[82:83], v7 offset:5792
    ds_read_b64_tr_b16 v[84:85], v7 offset:6432
    ds_read_b64_tr_b16 v[86:87], v7 offset:7072
    ds_read_b64_tr_b16 v[88:89], v7 offset:7712
    ds_read_b64_tr_b16 v[90:91], v7 offset:8352
    ds_read_b64_tr_b16 v[92:93], v7 offset:8992
    ds_read_b64_tr_b16 v[94:95], v7 offset:9632
    ds_read_b64_tr_b16 v[96:97], v7 offset:10272
    s_waitcnt lgkmcnt(0)
    v_mfma_f32_16x16x32_bf16 v[24:27], v[64:67], v[132:135], v[24:27]
    v_mfma_f32_16x16x32_bf16 v[24:27], v[68:71], v[136:139], v[24:27]
    v_mfma_f32_16x16x32_bf16 v[24:27], v[72:75], v[140:143], v[24:27]
    v_mfma_f32_16x16x32_bf16 v[24:27], v[76:79], v[144:147], v[24:27]
    v_mfma_f32_16x16x32_bf16 v[24:27], v[80:83], v[148:151], v[24:27]
    v_mfma_f32_16x16x32_bf16 v[24:27], v[84:87], v[152:155], v[24:27]
    v_mfma_f32_16x16x32_bf16 v[24:27], v[88:91], v[156:159], v[24:27]
    v_mfma_f32_16x16x32_bf16 v[24:27], v[92:95], v[160:163], v[24:27]
    s_nop 7
    v_mfma_f32_16x16x16_bf16 v[24:27], v[96:97], v[164:165], v[24:27]
    s_nop 7
    s_nop 7
    v_mul_f32 v20, v20, v18
    v_mul_f32 v21, v21, v18
    v_mul_f32 v22, v22, v18
    v_mul_f32 v23, v23, v18
    v_mul_f32 v24, v24, v18
    v_mul_f32 v25, v25, v18
    v_mul_f32 v26, v26, v18
    v_mul_f32 v27, v27, v18
    v_cvt_pk_bf16_f32 v28, v20, v21
    v_cvt_pk_bf16_f32 v29, v22, v23
    v_cvt_pk_bf16_f32 v30, v24, v25
    v_cvt_pk_bf16_f32 v31, v26, v27
    s_and_b32 s27, s43, 2047
    v_add_u32 v5, s27, v3
    v_mul_u32_u24 v5, 1280, v5
    v_lshl_add_u32 v5, v4, 3, v5
    s_mul_i32 s27, s42, 40
    s_add_u32 s27, s27, 14942208
    buffer_store_dwordx2 v[28:29], v5, s[20:23], s27 offen
    v_cmp_eq_u32 vcc, 0, v4
    s_and_saveexec_b64 s[28:29], vcc
    buffer_store_dwordx2 v[30:31], v5, s[20:23], s27 offen offset:32
k2_end:
    s_endpgm
.globl k3_kernel
.p2align 8
.type k3_kernel,@function
k3_kernel:
    s_load_dwordx16 s[44:59], s[0:1], 0
    s_load_dwordx4 s[60:63], s[0:1], 64
    s_load_dwordx2 s[64:65], s[0:1], 80
    s_waitcnt lgkmcnt(0)
    s_cmp_ge_u32 s2, 160
    s_cbranch_scc1 k3_end
    s_mov_b32 s20, s64
    s_and_b32 s21, s65, 0xffff
    s_mov_b32 s22, 268435456
    s_mov_b32 s23, 0x20000
    s_mov_b32 s68, s60
    s_and_b32 s69, s61, 0xffff
    s_mov_b32 s70, 2621440
    s_mov_b32 s71, 0x20000
    s_mov_b32 s8, s64
    s_and_b32 s9, s65, 0xffff
    s_mov_b32 s10, 268435456
    s_mov_b32 s11, 0x20000
    s_mov_b32 s12, s48
    s_and_b32 s13, s49, 0xffff
    s_mov_b32 s14, 819200
    s_mov_b32 s15, 0x20000
    s_mov_b32 s16, s48
    s_and_b32 s17, s49, 0xffff
    s_mov_b32 s18, 819200
    s_mov_b32 s19, 0x20000
    s_and_b32 s41, s2, 31
    s_lshr_b32 s42, s2, 5
    s_mul_i32 s31, s41, 81920
    s_add_u32 s31, s31, 14942208
    s_mov_b32 s30, 1280
    s_lshl_b32 s32, s42, 8
    s_add_u32 s33, s32, 128
    v_lshrrev_b32 v1, 6, v0
    v_and_b32 v2, 63, v0
    s_nop 0
    v_readfirstlane_b32 s36, v1
    v_lshrrev_b32 v3, 3, v2
    v_and_b32 v4, 7, v2
    s_mul_i32 s37, s36, 16
    v_xor_b32 v5, v4, v3
    v_lshlrev_b32 v5, 4, v5
    v_add_u32 v6, s37, v3
    s_mov_b32 s27, 1280
    v_mul_lo_u32 v6, v6, s27
    v_add_u32 v10, v6, v5
    s_lshl_b32 s27, s36, 4
    v_add_u32 v6, s27, v3
    v_and_b32 v7, 2, v3
    v_xor_b32 v7, v7, v4
    v_mul_lo_u32 v8, v6, s30
    v_lshl_add_u32 v11, v7, 4, v8
    v_add_u32 v6, 8, v6
    v_xor_b32 v7, 4, v7
    v_mul_lo_u32 v8, v6, s30
    v_lshl_add_u32 v12, v7, 4, v8
    s_mul_i32 s38, s36, 2048
    s_lshl_b32 s39, s36, 11
    s_add_u32 s39, s39, 8192
    s_lshl_b32 s40, s30, 6
    s_lshr_b32 s34, s36, 1
    s_and_b32 s35, s36, 1
    v_and_b32 v3, 15, v2
    v_lshrrev_b32 v4, 4, v2
    s_mul_i32 s27, s34, 4096
    v_and_b32 v5, 7, v3
    v_xor_b32 v5, v5, v4
    v_lshlrev_b32 v5, 4, v5
    v_lshl_add_u32 v5, v3, 7, v5
    v_add_u32 v13, s27, v5
    v_xor_b32 v14, 64, v13
    v_lshrrev_b32 v5, 2, v3
    v_and_b32 v6, 3, v3
    v_and_b32 v7, 2, v5
    v_and_b32 v8, 1, v4
    v_lshl_add_u32 v7, v8, 2, v7
    v_lshl_add_u32 v8, v4, 3, v5
    v_lshlrev_b32 v8, 7, v8
    v_and_b32 v9, 1, v6
    v_lshl_add_u32 v8, v9, 3, v8
    v_add_u32 v8, 8192, v8
    v_lshrrev_b32 v9, 1, v6
    s_lshl_b32 s27, s35, 2
    v_add_u32 v15, 0, v9
    v_add_u32 v15, s27, v15
    v_xor_b32 v15, v15, v7
    v_lshl_add_u32 v15, v15, 4, v8
    v_add_u32 v16, 2, v9
    v_add_u32 v16, s27, v16
    v_xor_b32 v16, v16, v7
    v_lshl_add_u32 v16, v16, 4, v8
    v_mov_b32 v64, 0
    v_mov_b32 v65, 0
    v_mov_b32 v66, 0
    v_mov_b32 v67, 0
    v_mov_b32 v68, 0
    v_mov_b32 v69, 0
    v_mov_b32 v70, 0
    v_mov_b32 v71, 0
    v_mov_b32 v72, 0
    v_mov_b32 v73, 0
    v_mov_b32 v74, 0
    v_mov_b32 v75, 0
    v_mov_b32 v76, 0
    v_mov_b32 v77, 0
    v_mov_b32 v78, 0
    v_mov_b32 v79, 0
    v_mov_b32 v80, 0
    v_mov_b32 v81, 0
    v_mov_b32 v82, 0
    v_mov_b32 v83, 0
    v_mov_b32 v84, 0
    v_mov_b32 v85, 0
    v_mov_b32 v86, 0
    v_mov_b32 v87, 0
    v_mov_b32 v88, 0
    v_mov_b32 v89, 0
    v_mov_b32 v90, 0
    v_mov_b32 v91, 0
    v_mov_b32 v92, 0
    v_mov_b32 v93, 0
    v_mov_b32 v94, 0
    v_mov_b32 v95, 0
    s_mov_b32 s24, s31
    s_mov_b32 s25, 0
    s_mov_b32 s26, 10
    s_add_u32 m0, s38, 0
    s_add_u32 s27, s24, 0
    buffer_load_dwordx4 v10, s[8:11], s27 offen lds
    s_add_u32 m0, s38, 1024
    s_add_u32 s27, s24, 10240
    buffer_load_dwordx4 v10, s[8:11], s27 offen lds
    s_add_u32 m0, s39, 0
    s_add_u32 s27, s25, s32
    buffer_load_dwordx4 v11, s[12:15], s27 offen lds
    s_add_u32 m0, s39, 1024
    s_add_u32 s27, s25, s32
    buffer_load_dwordx4 v12, s[12:15], s27 offen lds
    s_add_u32 m0, s39, 8192
    s_add_u32 s27, s25, s33
    buffer_load_dwordx4 v11, s[16:19], s27 offen lds
    s_add_u32 m0, s39, 9216
    s_add_u32 s27, s25, s33
    buffer_load_dwordx4 v12, s[16:19], s27 offen lds
    s_add_u32 s24, s24, 128
    s_add_u32 s25, s25, s40
    s_add_u32 m0, s38, 24576
    s_add_u32 s27, s24, 0
    buffer_load_dwordx4 v10, s[8:11], s27 offen lds
    s_add_u32 m0, s38, 25600
    s_add_u32 s27, s24, 10240
    buffer_load_dwordx4 v10, s[8:11], s27 offen lds
    s_add_u32 m0, s39, 24576
    s_add_u32 s27, s25, s32
    buffer_load_dwordx4 v11, s[12:15], s27 offen lds
    s_add_u32 m0, s39, 25600
    s_add_u32 s27, s25, s32
    buffer_load_dwordx4 v12, s[12:15], s27 offen lds
    s_add_u32 m0, s39, 32768
    s_add_u32 s27, s25, s33
    buffer_load_dwordx4 v11, s[16:19], s27 offen lds
    s_add_u32 m0, s39, 33792
    s_add_u32 s27, s25, s33
    buffer_load_dwordx4 v12, s[16:19], s27 offen lds
    s_add_u32 s24, s24, 128
    s_add_u32 s25, s25, s40
k3_loop:
    s_waitcnt vmcnt(6)
    s_barrier
    s_add_u32 m0, s38, 49152
    s_add_u32 s27, s24, 0
    buffer_load_dwordx4 v10, s[8:11], s27 offen lds
    s_add_u32 m0, s38, 50176
    s_add_u32 s27, s24, 10240
    buffer_load_dwordx4 v10, s[8:11], s27 offen lds
    s_add_u32 m0, s39, 49152
    s_add_u32 s27, s25, s32
    buffer_load_dwordx4 v11, s[12:15], s27 offen lds
    s_add_u32 m0, s39, 50176
    s_add_u32 s27, s25, s32
    buffer_load_dwordx4 v12, s[12:15], s27 offen lds
    s_add_u32 m0, s39, 57344
    s_add_u32 s27, s25, s33
    buffer_load_dwordx4 v11, s[16:19], s27 offen lds
    s_add_u32 m0, s39, 58368
    s_add_u32 s27, s25, s33
    buffer_load_dwordx4 v12, s[16:19], s27 offen lds
    s_add_u32 s24, s24, 128
    s_add_u32 s25, s25, s40
    ds_read_b128 v[128:131], v13 offset:0
    ds_read_b128 v[132:135], v13 offset:2048
    ds_read_b64_tr_b16 v[144:145], v15 offset:0
    ds_read_b64_tr_b16 v[146:147], v15 offset:512
    ds_read_b64_tr_b16 v[148:149], v16 offset:0
    ds_read_b64_tr_b16 v[150:151], v16 offset:512
    ds_read_b64_tr_b16 v[152:153], v15 offset:8192
    ds_read_b64_tr_b16 v[154:155], v15 offset:8704
    ds_read_b64_tr_b16 v[156:157], v16 offset:8192
    ds_read_b64_tr_b16 v[158:159], v16 offset:8704
    ds_read_b128 v[160:163], v14 offset:0
    ds_read_b128 v[164:167], v14 offset:2048
    ds_read_b64_tr_b16 v[176:177], v15 offset:4096
    ds_read_b64_tr_b16 v[178:179], v15 offset:4608
    ds_read_b64_tr_b16 v[180:181], v16 offset:4096
    ds_read_b64_tr_b16 v[182:183], v16 offset:4608
    ds_read_b64_tr_b16 v[184:185], v15 offset:12288
    ds_read_b64_tr_b16 v[186:187], v15 offset:12800
    ds_read_b64_tr_b16 v[188:189], v16 offset:12288
    ds_read_b64_tr_b16 v[190:191], v16 offset:12800
    s_waitcnt lgkmcnt(10)
    v_mfma_f32_16x16x32_bf16 v[64:67], v[144:147], v[128:131], v[64:67]
    v_mfma_f32_16x16x32_bf16 v[68:71], v[144:147], v[132:135], v[68:71]
    v_mfma_f32_16x16x32_bf16 v[72:75], v[148:151], v[128:131], v[72:75]
    v_mfma_f32_16x16x32_bf16 v[76:79], v[148:151], v[132:135], v[76:79]
    v_mfma_f32_16x16x32_bf16 v[80:83], v[152:155], v[128:131], v[80:83]
    v_mfma_f32_16x16x32_bf16 v[84:87], v[152:155], v[132:135], v[84:87]
    v_mfma_f32_16x16x32_bf16 v[88:91], v[156:159], v[128:131], v[88:91]
    v_mfma_f32_16x16x32_bf16 v[92:95], v[156:159], v[132:135], v[92:95]
    s_waitcnt lgkmcnt(0)
    v_mfma_f32_16x16x32_bf16 v[64:67], v[176:179], v[160:163], v[64:67]
    v_mfma_f32_16x16x32_bf16 v[68:71], v[176:179], v[164:167], v[68:71]
    v_mfma_f32_16x16x32_bf16 v[72:75], v[180:183], v[160:163], v[72:75]
    v_mfma_f32_16x16x32_bf16 v[76:79], v[180:183], v[164:167], v[76:79]
    v_mfma_f32_16x16x32_bf16 v[80:83], v[184:187], v[160:163], v[80:83]
    v_mfma_f32_16x16x32_bf16 v[84:87], v[184:187], v[164:167], v[84:87]
    v_mfma_f32_16x16x32_bf16 v[88:91], v[188:191], v[160:163], v[88:91]
    v_mfma_f32_16x16x32_bf16 v[92:95], v[188:191], v[164:167], v[92:95]
    s_sub_u32 s26, s26, 1
    s_cmp_eq_u32 s26, 0
    s_cbranch_scc1 k3_done
    s_waitcnt vmcnt(6)
    s_barrier
    s_add_u32 m0, s38, 0
    s_add_u32 s27, s24, 0
    buffer_load_dwordx4 v10, s[8:11], s27 offen lds
    s_add_u32 m0, s38, 1024
    s_add_u32 s27, s24, 10240
    buffer_load_dwordx4 v10, s[8:11], s27 offen lds
    s_add_u32 m0, s39, 0
    s_add_u32 s27, s25, s32
    buffer_load_dwordx4 v11, s[12:15], s27 offen lds
    s_add_u32 m0, s39, 1024
    s_add_u32 s27, s25, s32
    buffer_load_dwordx4 v12, s[12:15], s27 offen lds
    s_add_u32 m0, s39, 8192
    s_add_u32 s27, s25, s33
    buffer_load_dwordx4 v11, s[16:19], s27 offen lds
    s_add_u32 m0, s39, 9216
    s_add_u32 s27, s25, s33
    buffer_load_dwordx4 v12, s[16:19], s27 offen lds
    s_add_u32 s24, s24, 128
    s_add_u32 s25, s25, s40
    ds_read_b128 v[128:131], v13 offset:24576
    ds_read_b128 v[132:135], v13 offset:26624
    ds_read_b64_tr_b16 v[144:145], v15 offset:24576
    ds_read_b64_tr_b16 v[146:147], v15 offset:25088
    ds_read_b64_tr_b16 v[148:149], v16 offset:24576
    ds_read_b64_tr_b16 v[150:151], v16 offset:25088
    ds_read_b64_tr_b16 v[152:153], v15 offset:32768
    ds_read_b64_tr_b16 v[154:155], v15 offset:33280
    ds_read_b64_tr_b16 v[156:157], v16 offset:32768
    ds_read_b64_tr_b16 v[158:159], v16 offset:33280
    ds_read_b128 v[160:163], v14 offset:24576
    ds_read_b128 v[164:167], v14 offset:26624
    ds_read_b64_tr_b16 v[176:177], v15 offset:28672
    ds_read_b64_tr_b16 v[178:179], v15 offset:29184
    ds_read_b64_tr_b16 v[180:181], v16 offset:28672
    ds_read_b64_tr_b16 v[182:183], v16 offset:29184
    ds_read_b64_tr_b16 v[184:185], v15 offset:36864
    ds_read_b64_tr_b16 v[186:187], v15 offset:37376
    ds_read_b64_tr_b16 v[188:189], v16 offset:36864
    ds_read_b64_tr_b16 v[190:191], v16 offset:37376
    s_waitcnt lgkmcnt(10)
    v_mfma_f32_16x16x32_bf16 v[64:67], v[144:147], v[128:131], v[64:67]
    v_mfma_f32_16x16x32_bf16 v[68:71], v[144:147], v[132:135], v[68:71]
    v_mfma_f32_16x16x32_bf16 v[72:75], v[148:151], v[128:131], v[72:75]
    v_mfma_f32_16x16x32_bf16 v[76:79], v[148:151], v[132:135], v[76:79]
    v_mfma_f32_16x16x32_bf16 v[80:83], v[152:155], v[128:131], v[80:83]
    v_mfma_f32_16x16x32_bf16 v[84:87], v[152:155], v[132:135], v[84:87]
    v_mfma_f32_16x16x32_bf16 v[88:91], v[156:159], v[128:131], v[88:91]
    v_mfma_f32_16x16x32_bf16 v[92:95], v[156:159], v[132:135], v[92:95]
    s_waitcnt lgkmcnt(0)
    v_mfma_f32_16x16x32_bf16 v[64:67], v[176:179], v[160:163], v[64:67]
    v_mfma_f32_16x16x32_bf16 v[68:71], v[176:179], v[164:167], v[68:71]
    v_mfma_f32_16x16x32_bf16 v[72:75], v[180:183], v[160:163], v[72:75]
    v_mfma_f32_16x16x32_bf16 v[76:79], v[180:183], v[164:167], v[76:79]
    v_mfma_f32_16x16x32_bf16 v[80:83], v[184:187], v[160:163], v[80:83]
    v_mfma_f32_16x16x32_bf16 v[84:87], v[184:187], v[164:167], v[84:87]
    v_mfma_f32_16x16x32_bf16 v[88:91], v[188:191], v[160:163], v[88:91]
    v_mfma_f32_16x16x32_bf16 v[92:95], v[188:191], v[164:167], v[92:95]
    s_sub_u32 s26, s26, 1
    s_cmp_eq_u32 s26, 0
    s_cbranch_scc1 k3_done
    s_waitcnt vmcnt(6)
    s_barrier
    s_add_u32 m0, s38, 24576
    s_add_u32 s27, s24, 0
    buffer_load_dwordx4 v10, s[8:11], s27 offen lds
    s_add_u32 m0, s38, 25600
    s_add_u32 s27, s24, 10240
    buffer_load_dwordx4 v10, s[8:11], s27 offen lds
    s_add_u32 m0, s39, 24576
    s_add_u32 s27, s25, s32
    buffer_load_dwordx4 v11, s[12:15], s27 offen lds
    s_add_u32 m0, s39, 25600
    s_add_u32 s27, s25, s32
    buffer_load_dwordx4 v12, s[12:15], s27 offen lds
    s_add_u32 m0, s39, 32768
    s_add_u32 s27, s25, s33
    buffer_load_dwordx4 v11, s[16:19], s27 offen lds
    s_add_u32 m0, s39, 33792
    s_add_u32 s27, s25, s33
    buffer_load_dwordx4 v12, s[16:19], s27 offen lds
    s_add_u32 s24, s24, 128
    s_add_u32 s25, s25, s40
    ds_read_b128 v[128:131], v13 offset:49152
    ds_read_b128 v[132:135], v13 offset:51200
    ds_read_b64_tr_b16 v[144:145], v15 offset:49152
    ds_read_b64_tr_b16 v[146:147], v15 offset:49664
    ds_read_b64_tr_b16 v[148:149], v16 offset:49152
    ds_read_b64_tr_b16 v[150:151], v16 offset:49664
    ds_read_b64_tr_b16 v[152:153], v15 offset:57344
    ds_read_b64_tr_b16 v[154:155], v15 offset:57856
    ds_read_b64_tr_b16 v[156:157], v16 offset:57344
    ds_read_b64_tr_b16 v[158:159], v16 offset:57856
    ds_read_b128 v[160:163], v14 offset:49152
    ds_read_b128 v[164:167], v14 offset:51200
    ds_read_b64_tr_b16 v[176:177], v15 offset:53248
    ds_read_b64_tr_b16 v[178:179], v15 offset:53760
    ds_read_b64_tr_b16 v[180:181], v16 offset:53248
    ds_read_b64_tr_b16 v[182:183], v16 offset:53760
    ds_read_b64_tr_b16 v[184:185], v15 offset:61440
    ds_read_b64_tr_b16 v[186:187], v15 offset:61952
    ds_read_b64_tr_b16 v[188:189], v16 offset:61440
    ds_read_b64_tr_b16 v[190:191], v16 offset:61952
    s_waitcnt lgkmcnt(10)
    v_mfma_f32_16x16x32_bf16 v[64:67], v[144:147], v[128:131], v[64:67]
    v_mfma_f32_16x16x32_bf16 v[68:71], v[144:147], v[132:135], v[68:71]
    v_mfma_f32_16x16x32_bf16 v[72:75], v[148:151], v[128:131], v[72:75]
    v_mfma_f32_16x16x32_bf16 v[76:79], v[148:151], v[132:135], v[76:79]
    v_mfma_f32_16x16x32_bf16 v[80:83], v[152:155], v[128:131], v[80:83]
    v_mfma_f32_16x16x32_bf16 v[84:87], v[152:155], v[132:135], v[84:87]
    v_mfma_f32_16x16x32_bf16 v[88:91], v[156:159], v[128:131], v[88:91]
    v_mfma_f32_16x16x32_bf16 v[92:95], v[156:159], v[132:135], v[92:95]
    s_waitcnt lgkmcnt(0)
    v_mfma_f32_16x16x32_bf16 v[64:67], v[176:179], v[160:163], v[64:67]
    v_mfma_f32_16x16x32_bf16 v[68:71], v[176:179], v[164:167], v[68:71]
    v_mfma_f32_16x16x32_bf16 v[72:75], v[180:183], v[160:163], v[72:75]
    v_mfma_f32_16x16x32_bf16 v[76:79], v[180:183], v[164:167], v[76:79]
    v_mfma_f32_16x16x32_bf16 v[80:83], v[184:187], v[160:163], v[80:83]
    v_mfma_f32_16x16x32_bf16 v[84:87], v[184:187], v[164:167], v[84:87]
    v_mfma_f32_16x16x32_bf16 v[88:91], v[188:191], v[160:163], v[88:91]
    v_mfma_f32_16x16x32_bf16 v[92:95], v[188:191], v[164:167], v[92:95]
    s_sub_u32 s26, s26, 1
    s_cmp_eq_u32 s26, 0
    s_cbranch_scc1 k3_done
    s_branch k3_loop
k3_done:
    s_nop 15
    s_lshl_b32 s27, s41, 6
    s_lshl_b32 s43, s34, 5
    s_add_u32 s27, s27, s43
    v_add_u32 v6, s27, v3
    v_mul_u32_u24 v5, 1280, v6
    v_lshl_add_u32 v5, v4, 3, v5
    s_lshl_b32 s27, s35, 6
    s_add_u32 s27, s27, s32
    v_add_u32 v5, s27, v5
    v_lshlrev_b32 v6, 2, v6
    s_mov_b32 s27, 20185088
    buffer_load_dword v16, v6, s[20:23], s27 offen offset:0
    s_mov_b32 s27, 20185088
    buffer_load_dword v17, v6, s[20:23], s27 offen offset:64
    s_mov_b32 s27, 17563648
    buffer_load_dwordx2 v[128:129], v5, s[20:23], s27 offen
    s_mov_b32 s27, 17584128
    buffer_load_dwordx2 v[130:131], v5, s[20:23], s27 offen
    s_mov_b32 s27, 17563680
    buffer_load_dwordx2 v[132:133], v5, s[20:23], s27 offen
    s_mov_b32 s27, 17584160
    buffer_load_dwordx2 v[134:135], v5, s[20:23], s27 offen
    s_mov_b32 s27, 17563776
    buffer_load_dwordx2 v[136:137], v5, s[20:23], s27 offen
    s_mov_b32 s27, 17584256
    buffer_load_dwordx2 v[138:139], v5, s[20:23], s27 offen
    s_mov_b32 s27, 17563808
    buffer_load_dwordx2 v[140:141], v5, s[20:23], s27 offen
    s_mov_b32 s27, 17584288
    buffer_load_dwordx2 v[142:143], v5, s[20:23], s27 offen
    s_waitcnt vmcnt(0)
    v_sub_f32 v18, 1.0, v16
    v_cvt_pk_bf16_f32 v18, v18, v18
    v_lshlrev_b32 v18, 16, v18
    v_sub_f32 v19, 1.0, v17
    v_cvt_pk_bf16_f32 v19, v19, v19
    v_lshlrev_b32 v19, 16, v19
    v_cvt_pk_bf16_f32 v20, v64, v65
    v_cvt_pk_bf16_f32 v21, v66, v67
    v_lshlrev_b32 v24, 16, v20
    v_and_b32 v25, 0xffff0000, v20
    v_lshlrev_b32 v26, 16, v21
    v_and_b32 v27, 0xffff0000, v21
    v_lshlrev_b32 v28, 16, v128
    v_and_b32 v29, 0xffff0000, v128
    v_lshlrev_b32 v30, 16, v129
    v_and_b32 v31, 0xffff0000, v129
    v_mul_f32 v24, v24, v16
    v_mul_f32 v28, v28, v18
    v_mul_f32 v25, v25, v16
    v_mul_f32 v29, v29, v18
    v_mul_f32 v26, v26, v16
    v_mul_f32 v30, v30, v18
    v_mul_f32 v27, v27, v16
    v_mul_f32 v31, v31, v18
    v_cvt_pk_bf16_f32 v20, v24, v25
    v_cvt_pk_bf16_f32 v21, v26, v27
    v_cvt_pk_bf16_f32 v22, v28, v29
    v_cvt_pk_bf16_f32 v23, v30, v31
    v_lshlrev_b32 v24, 16, v20
    v_and_b32 v25, 0xffff0000, v20
    v_lshlrev_b32 v26, 16, v21
    v_and_b32 v27, 0xffff0000, v21
    v_lshlrev_b32 v28, 16, v22
    v_and_b32 v29, 0xffff0000, v22
    v_lshlrev_b32 v30, 16, v23
    v_and_b32 v31, 0xffff0000, v23
    v_add_f32 v24, v24, v28
    v_add_f32 v25, v25, v29
    v_add_f32 v26, v26, v30
    v_add_f32 v27, v27, v31
    v_cvt_pk_bf16_f32 v128, v24, v25
    v_cvt_pk_bf16_f32 v129, v26, v27
    s_mov_b32 s27, 0
    buffer_store_dwordx2 v[128:129], v5, s[68:71], s27 offen
    v_cvt_pk_bf16_f32 v20, v68, v69
    v_cvt_pk_bf16_f32 v21, v70, v71
    v_lshlrev_b32 v24, 16, v20
    v_and_b32 v25, 0xffff0000, v20
    v_lshlrev_b32 v26, 16, v21
    v_and_b32 v27, 0xffff0000, v21
    v_lshlrev_b32 v28, 16, v130
    v_and_b32 v29, 0xffff0000, v130
    v_lshlrev_b32 v30, 16, v131
    v_and_b32 v31, 0xffff0000, v131
    v_mul_f32 v24, v24, v17
    v_mul_f32 v28, v28, v19
    v_mul_f32 v25, v25, v17
    v_mul_f32 v29, v29, v19
    v_mul_f32 v26, v26, v17
    v_mul_f32 v30, v30, v19
    v_mul_f32 v27, v27, v17
    v_mul_f32 v31, v31, v19
    v_cvt_pk_bf16_f32 v20, v24, v25
    v_cvt_pk_bf16_f32 v21, v26, v27
    v_cvt_pk_bf16_f32 v22, v28, v29
    v_cvt_pk_bf16_f32 v23, v30, v31
    v_lshlrev_b32 v24, 16, v20
    v_and_b32 v25, 0xffff0000, v20
    v_lshlrev_b32 v26, 16, v21
    v_and_b32 v27, 0xffff0000, v21
    v_lshlrev_b32 v28, 16, v22
    v_and_b32 v29, 0xffff0000, v22
    v_lshlrev_b32 v30, 16, v23
    v_and_b32 v31, 0xffff0000, v23
    v_add_f32 v24, v24, v28
    v_add_f32 v25, v25, v29
    v_add_f32 v26, v26, v30
    v_add_f32 v27, v27, v31
    v_cvt_pk_bf16_f32 v130, v24, v25
    v_cvt_pk_bf16_f32 v131, v26, v27
    s_mov_b32 s27, 20480
    buffer_store_dwordx2 v[130:131], v5, s[68:71], s27 offen
    v_cvt_pk_bf16_f32 v20, v72, v73
    v_cvt_pk_bf16_f32 v21, v74, v75
    v_lshlrev_b32 v24, 16, v20
    v_and_b32 v25, 0xffff0000, v20
    v_lshlrev_b32 v26, 16, v21
    v_and_b32 v27, 0xffff0000, v21
    v_lshlrev_b32 v28, 16, v132
    v_and_b32 v29, 0xffff0000, v132
    v_lshlrev_b32 v30, 16, v133
    v_and_b32 v31, 0xffff0000, v133
    v_mul_f32 v24, v24, v16
    v_mul_f32 v28, v28, v18
    v_mul_f32 v25, v25, v16
    v_mul_f32 v29, v29, v18
    v_mul_f32 v26, v26, v16
    v_mul_f32 v30, v30, v18
    v_mul_f32 v27, v27, v16
    v_mul_f32 v31, v31, v18
    v_cvt_pk_bf16_f32 v20, v24, v25
    v_cvt_pk_bf16_f32 v21, v26, v27
    v_cvt_pk_bf16_f32 v22, v28, v29
    v_cvt_pk_bf16_f32 v23, v30, v31
    v_lshlrev_b32 v24, 16, v20
    v_and_b32 v25, 0xffff0000, v20
    v_lshlrev_b32 v26, 16, v21
    v_and_b32 v27, 0xffff0000, v21
    v_lshlrev_b32 v28, 16, v22
    v_and_b32 v29, 0xffff0000, v22
    v_lshlrev_b32 v30, 16, v23
    v_and_b32 v31, 0xffff0000, v23
    v_add_f32 v24, v24, v28
    v_add_f32 v25, v25, v29
    v_add_f32 v26, v26, v30
    v_add_f32 v27, v27, v31
    v_cvt_pk_bf16_f32 v132, v24, v25
    v_cvt_pk_bf16_f32 v133, v26, v27
    s_mov_b32 s27, 32
    buffer_store_dwordx2 v[132:133], v5, s[68:71], s27 offen
    v_cvt_pk_bf16_f32 v20, v76, v77
    v_cvt_pk_bf16_f32 v21, v78, v79
    v_lshlrev_b32 v24, 16, v20
    v_and_b32 v25, 0xffff0000, v20
    v_lshlrev_b32 v26, 16, v21
    v_and_b32 v27, 0xffff0000, v21
    v_lshlrev_b32 v28, 16, v134
    v_and_b32 v29, 0xffff0000, v134
    v_lshlrev_b32 v30, 16, v135
    v_and_b32 v31, 0xffff0000, v135
    v_mul_f32 v24, v24, v17
    v_mul_f32 v28, v28, v19
    v_mul_f32 v25, v25, v17
    v_mul_f32 v29, v29, v19
    v_mul_f32 v26, v26, v17
    v_mul_f32 v30, v30, v19
    v_mul_f32 v27, v27, v17
    v_mul_f32 v31, v31, v19
    v_cvt_pk_bf16_f32 v20, v24, v25
    v_cvt_pk_bf16_f32 v21, v26, v27
    v_cvt_pk_bf16_f32 v22, v28, v29
    v_cvt_pk_bf16_f32 v23, v30, v31
    v_lshlrev_b32 v24, 16, v20
    v_and_b32 v25, 0xffff0000, v20
    v_lshlrev_b32 v26, 16, v21
    v_and_b32 v27, 0xffff0000, v21
    v_lshlrev_b32 v28, 16, v22
    v_and_b32 v29, 0xffff0000, v22
    v_lshlrev_b32 v30, 16, v23
    v_and_b32 v31, 0xffff0000, v23
    v_add_f32 v24, v24, v28
    v_add_f32 v25, v25, v29
    v_add_f32 v26, v26, v30
    v_add_f32 v27, v27, v31
    v_cvt_pk_bf16_f32 v134, v24, v25
    v_cvt_pk_bf16_f32 v135, v26, v27
    s_mov_b32 s27, 20512
    buffer_store_dwordx2 v[134:135], v5, s[68:71], s27 offen
    v_cvt_pk_bf16_f32 v20, v80, v81
    v_cvt_pk_bf16_f32 v21, v82, v83
    v_lshlrev_b32 v24, 16, v20
    v_and_b32 v25, 0xffff0000, v20
    v_lshlrev_b32 v26, 16, v21
    v_and_b32 v27, 0xffff0000, v21
    v_lshlrev_b32 v28, 16, v136
    v_and_b32 v29, 0xffff0000, v136
    v_lshlrev_b32 v30, 16, v137
    v_and_b32 v31, 0xffff0000, v137
    v_mul_f32 v24, v24, v16
    v_mul_f32 v28, v28, v18
    v_mul_f32 v25, v25, v16
    v_mul_f32 v29, v29, v18
    v_mul_f32 v26, v26, v16
    v_mul_f32 v30, v30, v18
    v_mul_f32 v27, v27, v16
    v_mul_f32 v31, v31, v18
    v_cvt_pk_bf16_f32 v20, v24, v25
    v_cvt_pk_bf16_f32 v21, v26, v27
    v_cvt_pk_bf16_f32 v22, v28, v29
    v_cvt_pk_bf16_f32 v23, v30, v31
    v_lshlrev_b32 v24, 16, v20
    v_and_b32 v25, 0xffff0000, v20
    v_lshlrev_b32 v26, 16, v21
    v_and_b32 v27, 0xffff0000, v21
    v_lshlrev_b32 v28, 16, v22
    v_and_b32 v29, 0xffff0000, v22
    v_lshlrev_b32 v30, 16, v23
    v_and_b32 v31, 0xffff0000, v23
    v_add_f32 v24, v24, v28
    v_add_f32 v25, v25, v29
    v_add_f32 v26, v26, v30
    v_add_f32 v27, v27, v31
    v_cvt_pk_bf16_f32 v136, v24, v25
    v_cvt_pk_bf16_f32 v137, v26, v27
    s_mov_b32 s27, 128
    buffer_store_dwordx2 v[136:137], v5, s[68:71], s27 offen
    v_cvt_pk_bf16_f32 v20, v84, v85
    v_cvt_pk_bf16_f32 v21, v86, v87
    v_lshlrev_b32 v24, 16, v20
    v_and_b32 v25, 0xffff0000, v20
    v_lshlrev_b32 v26, 16, v21
    v_and_b32 v27, 0xffff0000, v21
    v_lshlrev_b32 v28, 16, v138
    v_and_b32 v29, 0xffff0000, v138
    v_lshlrev_b32 v30, 16, v139
    v_and_b32 v31, 0xffff0000, v139
    v_mul_f32 v24, v24, v17
    v_mul_f32 v28, v28, v19
    v_mul_f32 v25, v25, v17
    v_mul_f32 v29, v29, v19
    v_mul_f32 v26, v26, v17
    v_mul_f32 v30, v30, v19
    v_mul_f32 v27, v27, v17
    v_mul_f32 v31, v31, v19
    v_cvt_pk_bf16_f32 v20, v24, v25
    v_cvt_pk_bf16_f32 v21, v26, v27
    v_cvt_pk_bf16_f32 v22, v28, v29
    v_cvt_pk_bf16_f32 v23, v30, v31
    v_lshlrev_b32 v24, 16, v20
    v_and_b32 v25, 0xffff0000, v20
    v_lshlrev_b32 v26, 16, v21
    v_and_b32 v27, 0xffff0000, v21
    v_lshlrev_b32 v28, 16, v22
    v_and_b32 v29, 0xffff0000, v22
    v_lshlrev_b32 v30, 16, v23
    v_and_b32 v31, 0xffff0000, v23
    v_add_f32 v24, v24, v28
    v_add_f32 v25, v25, v29
    v_add_f32 v26, v26, v30
    v_add_f32 v27, v27, v31
    v_cvt_pk_bf16_f32 v138, v24, v25
    v_cvt_pk_bf16_f32 v139, v26, v27
    s_mov_b32 s27, 20608
    buffer_store_dwordx2 v[138:139], v5, s[68:71], s27 offen
    v_cvt_pk_bf16_f32 v20, v88, v89
    v_cvt_pk_bf16_f32 v21, v90, v91
    v_lshlrev_b32 v24, 16, v20
    v_and_b32 v25, 0xffff0000, v20
    v_lshlrev_b32 v26, 16, v21
    v_and_b32 v27, 0xffff0000, v21
    v_lshlrev_b32 v28, 16, v140
    v_and_b32 v29, 0xffff0000, v140
    v_lshlrev_b32 v30, 16, v141
    v_and_b32 v31, 0xffff0000, v141
    v_mul_f32 v24, v24, v16
    v_mul_f32 v28, v28, v18
    v_mul_f32 v25, v25, v16
    v_mul_f32 v29, v29, v18
    v_mul_f32 v26, v26, v16
    v_mul_f32 v30, v30, v18
    v_mul_f32 v27, v27, v16
    v_mul_f32 v31, v31, v18
    v_cvt_pk_bf16_f32 v20, v24, v25
    v_cvt_pk_bf16_f32 v21, v26, v27
    v_cvt_pk_bf16_f32 v22, v28, v29
    v_cvt_pk_bf16_f32 v23, v30, v31
    v_lshlrev_b32 v24, 16, v20
    v_and_b32 v25, 0xffff0000, v20
    v_lshlrev_b32 v26, 16, v21
    v_and_b32 v27, 0xffff0000, v21
    v_lshlrev_b32 v28, 16, v22
    v_and_b32 v29, 0xffff0000, v22
    v_lshlrev_b32 v30, 16, v23
    v_and_b32 v31, 0xffff0000, v23
    v_add_f32 v24, v24, v28
    v_add_f32 v25, v25, v29
    v_add_f32 v26, v26, v30
    v_add_f32 v27, v27, v31
    v_cvt_pk_bf16_f32 v140, v24, v25
    v_cvt_pk_bf16_f32 v141, v26, v27
    s_mov_b32 s27, 160
    buffer_store_dwordx2 v[140:141], v5, s[68:71], s27 offen
    v_cvt_pk_bf16_f32 v20, v92, v93
    v_cvt_pk_bf16_f32 v21, v94, v95
    v_lshlrev_b32 v24, 16, v20
    v_and_b32 v25, 0xffff0000, v20
    v_lshlrev_b32 v26, 16, v21
    v_and_b32 v27, 0xffff0000, v21
    v_lshlrev_b32 v28, 16, v142
    v_and_b32 v29, 0xffff0000, v142
    v_lshlrev_b32 v30, 16, v143
    v_and_b32 v31, 0xffff0000, v143
    v_mul_f32 v24, v24, v17
    v_mul_f32 v28, v28, v19
    v_mul_f32 v25, v25, v17
    v_mul_f32 v29, v29, v19
    v_mul_f32 v26, v26, v17
    v_mul_f32 v30, v30, v19
    v_mul_f32 v27, v27, v17
    v_mul_f32 v31, v31, v19
    v_cvt_pk_bf16_f32 v20, v24, v25
    v_cvt_pk_bf16_f32 v21, v26, v27
    v_cvt_pk_bf16_f32 v22, v28, v29
    v_cvt_pk_bf16_f32 v23, v30, v31
    v_lshlrev_b32 v24, 16, v20
    v_and_b32 v25, 0xffff0000, v20
    v_lshlrev_b32 v26, 16, v21
    v_and_b32 v27, 0xffff0000, v21
    v_lshlrev_b32 v28, 16, v22
    v_and_b32 v29, 0xffff0000, v22
    v_lshlrev_b32 v30, 16, v23
    v_and_b32 v31, 0xffff0000, v23
    v_add_f32 v24, v24, v28
    v_add_f32 v25, v25, v29
    v_add_f32 v26, v26, v30
    v_add_f32 v27, v27, v31
    v_cvt_pk_bf16_f32 v142, v24, v25
    v_cvt_pk_bf16_f32 v143, v26, v27
    s_mov_b32 s27, 20640
    buffer_store_dwordx2 v[142:143], v5, s[68:71], s27 offen
k3_end:
    s_endpgm
.section .rodata,"a"
.p2align 6
.amdhsa_kernel k1_kernel
  .amdhsa_next_free_vgpr 200
  .amdhsa_next_free_sgpr 80
  .amdhsa_accum_offset 200
  .amdhsa_group_segment_fixed_size 0
  .amdhsa_kernarg_size 88
  .amdhsa_user_sgpr_count 2
  .amdhsa_user_sgpr_kernarg_segment_ptr 1
  .amdhsa_system_sgpr_workgroup_id_x 1
.end_amdhsa_kernel
.p2align 6
.amdhsa_kernel k2_kernel
  .amdhsa_next_free_vgpr 200
  .amdhsa_next_free_sgpr 80
  .amdhsa_accum_offset 200
  .amdhsa_group_segment_fixed_size 0
  .amdhsa_kernarg_size 88
  .amdhsa_user_sgpr_count 2
  .amdhsa_user_sgpr_kernarg_segment_ptr 1
  .amdhsa_system_sgpr_workgroup_id_x 1
.end_amdhsa_kernel
.p2align 6
.amdhsa_kernel k3_kernel
  .amdhsa_next_free_vgpr 200
  .amdhsa_next_free_sgpr 80
  .amdhsa_accum_offset 200
  .amdhsa_group_segment_fixed_size 0
  .amdhsa_kernarg_size 88
  .amdhsa_user_sgpr_count 2
  .amdhsa_user_sgpr_kernarg_segment_ptr 1
  .amdhsa_system_sgpr_workgroup_id_x 1
.end_amdhsa_kernel
```
